```python
import torch

def _softmax(x, axis=-1):
    return torch.softmax(x, dim=axis)
def _gelu(x):
    return torch.nn.functional.gelu(x, approximate="tanh")
def _silu(x):
    return torch.nn.functional.silu(x)
def _sigmoid(x):
    return torch.sigmoid(x)
def _layernorm(x, axis=-1, eps=1e-5):
    m = x.mean(dim=axis, keepdim=True)
    v = x.var(dim=axis, keepdim=True, unbiased=False)
    return (x - m) / torch.sqrt(v + eps)
def _scatter_add(tgt, idx, src, axis=0):
    return tgt.clone().index_add_(axis, idx, src)
def _segment_sum(src, seg, n):
    out = torch.zeros((n,) + src.shape[1:], dtype=src.dtype)
    return out.index_add_(0, seg, src)
def _pad(x, pw):
    flat = tuple(v for pair in reversed(pw) for v in pair)
    return torch.nn.functional.pad(x, flat)

kernel_name = 'gather_scatter__hybrid_graph_tf_nagphormer__graph'

def setup_inputs():

    _w = (lambda a: (lambda t: t.to(torch.bfloat16) if t.is_floating_point() else t)(torch.as_tensor(a)))
    N, deg, D = 50000, 16, 64
    E = N * deg
    src = (lambda lo, hi, *s: torch.randint(lo, hi, s))(0, N, E).to(torch.int64)
    dst = (lambda lo, hi, *s: torch.randint(lo, hi, s))(0, N, E).to(torch.int64)
    deg_cnt = torch.bincount(dst, minlength=N).to(float) + 1.0
    sc = 1.0 / D ** 0.5
    return {
        "x": _w((lambda *s: torch.randn(*s, dtype=torch.bfloat16) * 0.1)(N, D)),
        "src": _w(src),
        "dst": _w(dst),
        "deg_inv_sqrt": _w(1.0 / (lambda _x: torch.sqrt(torch.as_tensor(_x)))(deg_cnt)),
        "wq": _w((lambda *s: torch.randn(*s, dtype=torch.bfloat16) * 3.2)(D, D) * sc),
        "wk": _w((lambda *s: torch.randn(*s, dtype=torch.bfloat16) * 3.2)(D, D) * sc),
        "wv": _w((lambda *s: torch.randn(*s, dtype=torch.bfloat16) * 0.1)(D, D) * sc),
        "wo": _w((lambda *s: torch.randn(*s, dtype=torch.bfloat16) * 0.1)(D, D) * sc),
        "w_r": _w((lambda *s: torch.randn(*s, dtype=torch.bfloat16) * 0.1)(D)),
    }

def reference(x, src, dst, deg_inv_sqrt, wq, wk, wv, wo, w_r):
    N, D = x.shape[0], x.shape[1]
    K = 7
    h = x
    toks = [x]
    for _ in range(K):
        msg = h[src] * deg_inv_sqrt[src, None] * deg_inv_sqrt[dst, None]
        h = _segment_sum(msg, dst, N)
        toks.append(h)
    tok = torch.stack(toks, axis=1)
    t = _layernorm(tok, axis=-1)
    q   = torch.einsum('nkd,de->nke', t, wq)
    key = torch.einsum('nkd,de->nke', t, wk)
    v   = torch.einsum('nkd,de->nke', t, wv)
    scale = 1.0 / (D ** 0.5)
    attn = _softmax(torch.einsum('nkd,nld->nkl', q, key) * scale, axis=-1)
    o = torch.einsum('nkl,nld->nkd', attn, v)
    o = tok + torch.einsum('nkd,de->nke', o, wo)
    r = _layernorm(o, axis=-1)
    alpha = _softmax(torch.einsum('nkd,d->nk', r, w_r), axis=-1)
    return torch.einsum('nk,nkd->nd', alpha, o)
```

```asm
; @launch grid=(256,1,1) block=(1024,1,1) lds=163840
.amdgcn_target "amdgcn-amd-amdhsa--gfx950"
.text
.globl gather_scatter__hybrid_graph_tf_nagphormer__graph_kernel
.p2align 8
.type gather_scatter__hybrid_graph_tf_nagphormer__graph_kernel,@function
gather_scatter__hybrid_graph_tf_nagphormer__graph_kernel:
    s_cmp_ge_u32 s2, 256
    s_cbranch_scc1 k_end
    s_load_dwordx16 s[8:23], s[0:1], 0
    s_load_dwordx8 s[24:31], s[0:1], 64
    v_lshrrev_b32 v1, 6, v0
    s_and_b32 s5, s2, 7
    v_readfirstlane_b32 s4, v1
    s_lshl_b32 s5, s5, 5
    s_lshr_b32 s3, s2, 3
    s_add_u32 s5, s5, s3
    s_mov_b32 s62, 0
    s_mul_i32 s54, s5, 196
    v_lshlrev_b32 v10, 4, v0
    s_cmp_ge_u32 s4, 13
    s_cbranch_scc1 p1_help
    v_lshrrev_b32 v2, 3, v0
    v_add_u32 v3, s54, v2
    v_add_u32 v4, 104, v3
    v_and_b32 v5, 7, v0
    v_lshlrev_b32 v5, 4, v5
    v_lshl_add_u32 v6, v3, 7, v5
    v_lshl_add_u32 v7, v4, 7, v5
    v_lshlrev_b32 v8, 1, v3
    v_lshlrev_b32 v9, 1, v4
    s_mul_i32 s55, s2, 12800
    v_add_u32 v11, s55, v10
    s_add_u32 s55, s55, 128
    s_mov_b32 s64, 50000
    v_cmp_gt_u32 s[48:49], s64, v3
    v_cmp_gt_u32 s[50:51], s64, v4
    s_movk_i32 s64, 736
    v_cmp_gt_u32 vcc, s64, v0
    s_and_b64 s[50:51], s[50:51], vcc
    s_movk_i32 s64, 800
    v_cmp_gt_u32 s[52:53], s64, v0
    s_cmp_ge_u32 s2, 250
    s_cselect_b64 s[52:53], 0, s[52:53]
    s_waitcnt lgkmcnt(0)
    s_mov_b64 exec, s[52:53]
    s_cbranch_execz p1_ne
    global_load_dwordx4 v[12:15], v11, s[12:13] nt
    global_load_dwordx4 v[16:19], v11, s[10:11] nt
p1_ne:
    s_mov_b64 exec, -1
    s_add_u32 s30, s30, 0x1fffff
    s_addc_u32 s31, s31, 0
    s_and_b32 s30, s30, 0xffe00000
    s_mov_b32 s36, s30
    s_mov_b32 s37, s31
    s_mov_b32 s38, 10485760
    s_mov_b32 s39, 0x20000
    s_add_u32 s40, s30, 88080384
    s_addc_u32 s41, s31, 0
    s_mov_b32 s42, 10485760
    s_mov_b32 s43, 0x20000
    s_getreg_b32 s7, hwreg(HW_REG_XCC_ID, 0, 4)
    s_lshr_b32 s6, s7, 2
    s_mov_b64 s[56:57], 0
    s_mov_b32 s44, s8
    s_mov_b32 s45, s9
    s_mov_b32 s46, 6400000
    s_mov_b32 s47, 0x20000
    s_add_u32 s96, s30, 62914560
    s_addc_u32 s97, s31, 0
    s_mov_b32 s98, 10485760
    s_mov_b32 s99, 0x20000
    s_mov_b32 s60, 0
    s_mov_b32 s93, 0
    s_and_b32 s6, s6, 1
    s_lshl_b32 s64, s2, 4
    s_add_u32 s64, s64, s4
    s_cmp_lg_u32 s64, 4080
    s_cbranch_scc1 p1_nz
    v_and_b32 v40, 15, v0
    v_lshrrev_b32 v41, 4, v0
    v_lshlrev_b32 v40, 8, v40
    v_and_b32 v42, 1, v41
    v_lshrrev_b32 v41, 1, v41
    v_lshl_add_u32 v40, v42, 12, v40
    v_lshl_add_u32 v40, v41, 13, v40
    v_add_u32 v40, 98566144, v40
    v_mov_b32 v41, 0
    global_store_dword v40, v41, s[30:31] sc1
    v_add_u32 v40, 0x4000, v40
    global_store_dword v40, v41, s[30:31] sc1
    v_add_u32 v40, 0x4000, v40
    global_store_dword v40, v41, s[30:31] sc1
    s_waitcnt vmcnt(0)
    s_mov_b64 exec, 1
    v_mov_b32 v40, 0
    v_mov_b32 v41, 1
    global_store_dword v40, v41, s[28:29] sc1
    s_mov_b64 exec, -1
p1_nz:
    v_mov_b32 v32, 0
    v_mov_b32 v36, 2147479552
    v_mov_b32 v33, 0
    v_mov_b32 v37, 2147479552
    v_mov_b32 v34, 0
    v_mov_b32 v38, 2147479552
    v_mov_b32 v35, 0
    v_mov_b32 v39, 2147479552
    ds_write_b128 v10, v[36:39] offset:52352
    v_add_u32 v1, 13312, v10
    ds_write_b128 v1, v[36:39] offset:52352
    v_add_u32 v1, 26624, v10
    s_movk_i32 s64, 416
    v_cmpx_gt_u32 vcc, s64, v0
    ds_write_b128 v1, v[36:39] offset:52352
    ds_write_b128 v10, v[32:35] offset:32896
    s_movk_i32 s64, 208
    v_cmpx_gt_u32 vcc, s64, v0
    ds_write_b128 v10, v[34:37] offset:28736
    s_movk_i32 s64, 84
    v_cmpx_gt_u32 vcc, s64, v0
    ds_write_b128 v10, v[32:35] offset:25344
    s_mov_b64 exec, -1
    v_lshrrev_b32 v64, 8, v3
    v_mul_u32_u24 v65, 205, v64
    v_lshl_add_u32 v76, v64, 7, v3
    v_lshrrev_b32 v65, 13, v65
    v_lshrrev_b32 v64, 1, v3
    v_lshl_add_u32 v76, v65, 10, v76
    v_bitop3_b32 v64, v64, v3, 64 bitop3:0x80
    v_add_u32 v76, v76, v64
    v_lshl_add_u32 v76, v76, 7, v5
    v_cndmask_b32 v76, v36, v76, s[48:49]
    v_and_b32 v64, 128, v3
    v_cmp_ne_u32 vcc, 0, v64
    s_nop 0
    v_add_u32 v77, 0x2000, v76
    v_cndmask_b32 v77, v36, v77, vcc
    v_lshrrev_b32 v64, 8, v4
    v_mul_u32_u24 v65, 205, v64
    v_lshl_add_u32 v78, v64, 7, v4
    v_lshrrev_b32 v65, 13, v65
    v_lshrrev_b32 v64, 1, v4
    v_lshl_add_u32 v78, v65, 10, v78
    v_bitop3_b32 v64, v64, v4, 64 bitop3:0x80
    v_add_u32 v78, v78, v64
    v_lshl_add_u32 v78, v78, 7, v5
    v_cndmask_b32 v78, v36, v78, s[50:51]
    v_and_b32 v64, 128, v4
    v_cmp_ne_u32 vcc, 0, v64
    s_nop 0
    v_add_u32 v79, 0x2000, v78
    v_cndmask_b32 v79, v36, v79, vcc
    s_waitcnt lgkmcnt(0)
    s_barrier
    s_mov_b64 exec, s[52:53]
    s_cbranch_execz p1_e1
    s_movk_i32 s64, -196
    v_mov_b32 v33, 1
    s_waitcnt vmcnt(0)
    v_mul_u32_u24 v30, 85599, v12
    v_lshrrev_b32 v52, 24, v30
    v_lshlrev_b32 v40, 2, v52
    ds_add_rtn_u32 v48, v40, v33 offset:25344
    v_mul_u32_u24 v30, 85599, v13
    v_lshrrev_b32 v53, 24, v30
    v_lshlrev_b32 v41, 2, v53
    ds_add_rtn_u32 v49, v41, v33 offset:25344
    v_mul_u32_u24 v30, 85599, v14
    v_lshrrev_b32 v54, 24, v30
    v_lshlrev_b32 v42, 2, v54
    ds_add_rtn_u32 v50, v42, v33 offset:25344
    v_mul_u32_u24 v30, 85599, v15
    v_lshrrev_b32 v55, 24, v30
    v_lshlrev_b32 v43, 2, v55
    ds_add_rtn_u32 v51, v43, v33 offset:25344
p1_e1:
    s_mov_b64 exec, s[48:49]
    s_cbranch_execz p1_nxa
    global_load_dwordx4 v[20:23], v6, s[8:9]
    global_load_ushort v28, v8, s[14:15]
p1_nxa:
    s_mov_b64 exec, s[50:51]
    s_cbranch_execz p1_nxb
    global_load_dwordx4 v[24:27], v7, s[8:9]
    global_load_ushort v29, v9, s[14:15]
p1_nxb:
    s_mov_b64 exec, -1
    s_mov_b64 exec, -1
    s_waitcnt lgkmcnt(0)
    s_barrier
    s_cmp_lg_u32 s4, 0
    s_cbranch_scc1 p1_ns
    ds_read_b128 v[72:75], v10 offset:25344
    s_waitcnt lgkmcnt(0)
    v_add_u32 v57, v72, v73
    v_add_u32 v58, v57, v74
    v_add_u32 v59, v58, v75
    v_mov_b32 v60, v59
    s_nop 1
    v_add_u32_dpp v60, v60, v60 row_shr:1 row_mask:0xf bank_mask:0xf bound_ctrl:0
    s_nop 1
    v_add_u32_dpp v60, v60, v60 row_shr:2 row_mask:0xf bank_mask:0xf bound_ctrl:0
    s_nop 1
    v_add_u32_dpp v60, v60, v60 row_shr:4 row_mask:0xf bank_mask:0xf bound_ctrl:0
    s_nop 1
    v_add_u32_dpp v60, v60, v60 row_shr:8 row_mask:0xf bank_mask:0xf bound_ctrl:0
    s_nop 1
    v_add_u32_dpp v60, v60, v60 row_bcast:15 row_mask:0xa bank_mask:0xf
    s_nop 1
    v_add_u32_dpp v60, v60, v60 row_bcast:31 row_mask:0xc bank_mask:0xf
    v_sub_u32 v60, v60, v59
    v_add_u32 v61, v60, v72
    v_add_u32 v62, v60, v57
    v_add_u32 v63, v60, v58
    ds_write_b128 v10, v[60:63] offset:25344
    v_lshl_or_b32 v56, v72, 16, v60
    v_lshl_or_b32 v57, v73, 16, v61
    v_lshl_or_b32 v58, v74, 16, v62
    v_lshl_or_b32 v59, v75, 16, v63
    s_cmp_ge_u32 s2, 250
    s_cbranch_scc1 p1_ns
    s_lshl_b32 s65, s2, 10
    s_add_u32 s65, s65, 4194304
    buffer_store_dwordx4 v[56:59], v10, s[40:43], s65 offen sc1
p1_ns:
    v_mul_u32_u24 v31, 10700, v16
    v_lshrrev_b32 v30, 5, v52
    v_lshrrev_b32 v31, 26, v31
    v_mad_i32_i24 v12, v52, s64, v12
    v_sub_u32 v31, v31, v30
    v_and_b32 v31, 7, v31
    v_lshl_add_u32 v12, v12, 3, v31
    v_lshrrev_b32 v30, 8, v16
    v_mul_u32_u24 v31, 205, v30
    v_lshl_add_u32 v44, v30, 7, v16
    v_lshrrev_b32 v31, 13, v31
    v_lshrrev_b32 v30, 1, v16
    v_lshl_add_u32 v44, v31, 10, v44
    v_bitop3_b32 v30, v30, v16, 64 bitop3:0x80
    v_add_u32 v44, v44, v30
    v_bfe_u32 v30, v16, 7, 1
    v_lshl_or_b32 v30, v12, 2, v30
    v_lshl_or_b32 v44, v44, 15, v30
    v_mul_u32_u24 v31, 10700, v17
    v_lshrrev_b32 v30, 5, v53
    v_lshrrev_b32 v31, 26, v31
    v_mad_i32_i24 v13, v53, s64, v13
    v_sub_u32 v31, v31, v30
    v_and_b32 v31, 7, v31
    v_lshl_add_u32 v13, v13, 3, v31
    v_lshrrev_b32 v30, 8, v17
    v_mul_u32_u24 v31, 205, v30
    v_lshl_add_u32 v45, v30, 7, v17
    v_lshrrev_b32 v31, 13, v31
    v_lshrrev_b32 v30, 1, v17
    v_lshl_add_u32 v45, v31, 10, v45
    v_bitop3_b32 v30, v30, v17, 64 bitop3:0x80
    v_add_u32 v45, v45, v30
    v_bfe_u32 v30, v17, 7, 1
    v_lshl_or_b32 v30, v13, 2, v30
    v_lshl_or_b32 v45, v45, 15, v30
    v_mul_u32_u24 v31, 10700, v18
    v_lshrrev_b32 v30, 5, v54
    v_lshrrev_b32 v31, 26, v31
    v_mad_i32_i24 v14, v54, s64, v14
    v_sub_u32 v31, v31, v30
    v_and_b32 v31, 7, v31
    v_lshl_add_u32 v14, v14, 3, v31
    v_lshrrev_b32 v30, 8, v18
    v_mul_u32_u24 v31, 205, v30
    v_lshl_add_u32 v46, v30, 7, v18
    v_lshrrev_b32 v31, 13, v31
    v_lshrrev_b32 v30, 1, v18
    v_lshl_add_u32 v46, v31, 10, v46
    v_bitop3_b32 v30, v30, v18, 64 bitop3:0x80
    v_add_u32 v46, v46, v30
    v_bfe_u32 v30, v18, 7, 1
    v_lshl_or_b32 v30, v14, 2, v30
    v_lshl_or_b32 v46, v46, 15, v30
    v_mul_u32_u24 v31, 10700, v19
    v_lshrrev_b32 v30, 5, v55
    v_lshrrev_b32 v31, 26, v31
    v_mad_i32_i24 v15, v55, s64, v15
    v_sub_u32 v31, v31, v30
    v_and_b32 v31, 7, v31
    v_lshl_add_u32 v15, v15, 3, v31
    v_lshrrev_b32 v30, 8, v19
    v_mul_u32_u24 v31, 205, v30
    v_lshl_add_u32 v47, v30, 7, v19
    v_lshrrev_b32 v31, 13, v31
    v_lshrrev_b32 v30, 1, v19
    v_lshl_add_u32 v47, v31, 10, v47
    v_bitop3_b32 v30, v30, v19, 64 bitop3:0x80
    v_add_u32 v47, v47, v30
    v_bfe_u32 v30, v19, 7, 1
    v_lshl_or_b32 v30, v15, 2, v30
    v_lshl_or_b32 v47, v47, 15, v30
    s_waitcnt lgkmcnt(0)
    s_barrier
    s_mov_b64 exec, s[52:53]
    ds_read_b32 v40, v40 offset:25344
    ds_read_b32 v41, v41 offset:25344
    ds_read_b32 v42, v42 offset:25344
    ds_read_b32 v43, v43 offset:25344
    s_waitcnt lgkmcnt(3)
    v_add_lshl_u32 v40, v40, v48, 2
    ds_write_b32 v40, v44 offset:39552
    s_waitcnt lgkmcnt(3)
    v_add_lshl_u32 v41, v41, v49, 2
    ds_write_b32 v41, v45 offset:39552
    s_waitcnt lgkmcnt(3)
    v_add_lshl_u32 v42, v42, v50, 2
    ds_write_b32 v42, v46 offset:39552
    s_waitcnt lgkmcnt(3)
    v_add_lshl_u32 v43, v43, v51, 2
    ds_write_b32 v43, v47 offset:39552
    s_mov_b64 exec, -1
    s_waitcnt lgkmcnt(0)
    s_barrier
    s_mov_b64 exec, s[52:53]
    s_cbranch_execz p1_e3
    ds_read_b128 v[40:43], v10 offset:39552
    s_waitcnt lgkmcnt(0)
    buffer_store_dwordx4 v[40:43], v10, s[40:43], s55 offen sc1
p1_e3:
    s_mov_b64 exec, -1
    s_waitcnt vmcnt(0)
    s_barrier
    s_mov_b32 s66, 0x3f803f80
    s_waitcnt vmcnt(0)
    s_mov_b64 exec, s[48:49]
    s_cbranch_execz xc1
    v_lshlrev_b32 v28, 16, v28
    v_lshlrev_b32 v64, 16, v20
    v_and_b32 v65, 0xffff0000, v20
    v_mul_f32 v64, v28, v64
    v_mul_f32 v65, v28, v65
    v_cvt_pk_bf16_f32 v68, v64, v65
    v_lshlrev_b32 v64, 16, v21
    v_and_b32 v65, 0xffff0000, v21
    v_mul_f32 v64, v28, v64
    v_mul_f32 v65, v28, v65
    v_cvt_pk_bf16_f32 v69, v64, v65
    v_lshlrev_b32 v64, 16, v22
    v_and_b32 v65, 0xffff0000, v22
    v_mul_f32 v64, v28, v64
    v_mul_f32 v65, v28, v65
    v_cvt_pk_bf16_f32 v70, v64, v65
    v_lshlrev_b32 v64, 16, v23
    v_and_b32 v65, 0xffff0000, v23
    v_mul_f32 v64, v28, v64
    v_mul_f32 v65, v28, v65
    v_cvt_pk_bf16_f32 v71, v64, v65
    buffer_store_dwordx4 v[68:71], v76, s[36:39], 0 offen sc1
    buffer_store_dwordx4 v[68:71], v77, s[36:39], 0 offen sc1
xc1:
    s_mov_b64 exec, s[50:51]
    s_cbranch_execz xc2
    v_lshlrev_b32 v29, 16, v29
    v_lshlrev_b32 v64, 16, v24
    v_and_b32 v65, 0xffff0000, v24
    v_mul_f32 v64, v29, v64
    v_mul_f32 v65, v29, v65
    v_cvt_pk_bf16_f32 v72, v64, v65
    v_lshlrev_b32 v64, 16, v25
    v_and_b32 v65, 0xffff0000, v25
    v_mul_f32 v64, v29, v64
    v_mul_f32 v65, v29, v65
    v_cvt_pk_bf16_f32 v73, v64, v65
    v_lshlrev_b32 v64, 16, v26
    v_and_b32 v65, 0xffff0000, v26
    v_mul_f32 v64, v29, v64
    v_mul_f32 v65, v29, v65
    v_cvt_pk_bf16_f32 v74, v64, v65
    v_lshlrev_b32 v64, 16, v27
    v_and_b32 v65, 0xffff0000, v27
    v_mul_f32 v64, v29, v64
    v_mul_f32 v65, v29, v65
    v_cvt_pk_bf16_f32 v75, v64, v65
    buffer_store_dwordx4 v[72:75], v78, s[36:39], 0 offen sc1
    buffer_store_dwordx4 v[72:75], v79, s[36:39], 0 offen sc1
xc2:
    s_mov_b64 exec, s[48:49]
    s_cbranch_execz xr3
    v_dot2_f32_bf16 v64, v20, s66, 0
    v_dot2_f32_bf16 v65, v20, v20, 0
    v_dot2_f32_bf16 v64, v21, s66, v64
    v_dot2_f32_bf16 v65, v21, v21, v65
    v_dot2_f32_bf16 v64, v22, s66, v64
    v_dot2_f32_bf16 v65, v22, v22, v65
    v_dot2_f32_bf16 v64, v23, s66, v64
    v_dot2_f32_bf16 v65, v23, v23, v65
    s_nop 2
    v_add_f32_dpp v64, v64, v64 quad_perm:[1,0,3,2] row_mask:0xf bank_mask:0xf
    v_add_f32_dpp v65, v65, v65 quad_perm:[1,0,3,2] row_mask:0xf bank_mask:0xf
    s_nop 0
    v_add_f32_dpp v64, v64, v64 quad_perm:[2,3,0,1] row_mask:0xf bank_mask:0xf
    v_add_f32_dpp v65, v65, v65 quad_perm:[2,3,0,1] row_mask:0xf bank_mask:0xf
    s_nop 0
    v_add_f32_dpp v64, v64, v64 row_half_mirror row_mask:0xf bank_mask:0xf
    v_add_f32_dpp v65, v65, v65 row_half_mirror row_mask:0xf bank_mask:0xf
    s_nop 0
    v_mul_f32 v64, 0x3c800000, v64
    v_mul_f32 v65, 0x3c800000, v65
    v_fma_f32 v65, -v64, v64, v65
    v_max_f32 v65, 0, v65
    v_add_f32 v65, 0x3727c5ac, v65
    v_rsq_f32 v64, v65
    s_nop 0
    v_mov_b32 v65, v28
    v_lshlrev_b32 v66, 3, v2
    ds_write_b64 v66, v[64:65] offset:26688
xr3:
    s_mov_b64 exec, s[50:51]
    s_cbranch_execz xr4
    v_dot2_f32_bf16 v64, v24, s66, 0
    v_dot2_f32_bf16 v65, v24, v24, 0
    v_dot2_f32_bf16 v64, v25, s66, v64
    v_dot2_f32_bf16 v65, v25, v25, v65
    v_dot2_f32_bf16 v64, v26, s66, v64
    v_dot2_f32_bf16 v65, v26, v26, v65
    v_dot2_f32_bf16 v64, v27, s66, v64
    v_dot2_f32_bf16 v65, v27, v27, v65
    s_nop 2
    v_add_f32_dpp v64, v64, v64 quad_perm:[1,0,3,2] row_mask:0xf bank_mask:0xf
    v_add_f32_dpp v65, v65, v65 quad_perm:[1,0,3,2] row_mask:0xf bank_mask:0xf
    s_nop 0
    v_add_f32_dpp v64, v64, v64 quad_perm:[2,3,0,1] row_mask:0xf bank_mask:0xf
    v_add_f32_dpp v65, v65, v65 quad_perm:[2,3,0,1] row_mask:0xf bank_mask:0xf
    s_nop 0
    v_add_f32_dpp v64, v64, v64 row_half_mirror row_mask:0xf bank_mask:0xf
    v_add_f32_dpp v65, v65, v65 row_half_mirror row_mask:0xf bank_mask:0xf
    s_nop 0
    v_mul_f32 v64, 0x3c800000, v64
    v_mul_f32 v65, 0x3c800000, v65
    v_fma_f32 v65, -v64, v64, v65
    v_max_f32 v65, 0, v65
    v_add_f32 v65, 0x3727c5ac, v65
    v_rsq_f32 v64, v65
    s_nop 0
    v_mov_b32 v65, v29
    v_lshlrev_b32 v66, 3, v2
    ds_write_b64 v66, v[64:65] offset:27520
xr4:
    s_mov_b64 exec, -1
    s_branch p1_done
p1_help:
    v_and_b32 v2, 63, v0
    v_and_b32 v3, 15, v0
    v_bfe_u32 v4, v0, 4, 2
    v_lshrrev_b32 v5, 2, v3
    v_and_b32 v6, 3, v0
    v_lshl_add_u32 v5, v5, 3, v6
    v_lshlrev_b32 v5, 7, v5
    v_lshl_add_u32 v5, v4, 4, v5
    v_add_u32 v7, 0x1000, v5
    s_waitcnt lgkmcnt(0)
    s_cmp_eq_u32 s4, 15
    s_cbranch_scc1 p1_probe
    s_barrier
    s_cmp_eq_u32 s4, 14
    s_cselect_b32 s64, s16, s20
    s_cselect_b32 s65, s17, s21
    global_load_dwordx4 v[12:15], v5, s[64:65] offset:0
    global_load_dwordx4 v[16:19], v5, s[64:65] offset:64
    global_load_dwordx4 v[20:23], v5, s[64:65] offset:512
    global_load_dwordx4 v[24:27], v5, s[64:65] offset:576
    global_load_dwordx4 v[28:31], v7, s[64:65] offset:0
    global_load_dwordx4 v[32:35], v7, s[64:65] offset:64
    global_load_dwordx4 v[36:39], v7, s[64:65] offset:512
    global_load_dwordx4 v[40:43], v7, s[64:65] offset:576
    s_cbranch_scc0 p1_wo
    global_load_dwordx4 v[44:47], v5, s[18:19] offset:0
    global_load_dwordx4 v[48:51], v5, s[18:19] offset:64
    global_load_dwordx4 v[52:55], v5, s[18:19] offset:512
    global_load_dwordx4 v[56:59], v5, s[18:19] offset:576
    global_load_dwordx4 v[60:63], v7, s[18:19] offset:0
    global_load_dwordx4 v[64:67], v7, s[18:19] offset:64
    global_load_dwordx4 v[68:71], v7, s[18:19] offset:512
    global_load_dwordx4 v[72:75], v7, s[18:19] offset:576
    s_add_u32 s30, s30, 0x1fffff
    s_addc_u32 s31, s31, 0
    s_and_b32 s30, s30, 0xffe00000
    s_mov_b32 s36, s30
    s_mov_b32 s37, s31
    s_mov_b32 s38, 10485760
    s_mov_b32 s39, 0x20000
    s_add_u32 s40, s30, 88080384
    s_addc_u32 s41, s31, 0
    s_mov_b32 s42, 10485760
    s_mov_b32 s43, 0x20000
    s_getreg_b32 s7, hwreg(HW_REG_XCC_ID, 0, 4)
    s_lshr_b32 s6, s7, 2
    s_mov_b64 s[56:57], 0
    s_mov_b32 s44, s8
    s_mov_b32 s45, s9
    s_mov_b32 s46, 6400000
    s_mov_b32 s47, 0x20000
    s_add_u32 s96, s30, 62914560
    s_addc_u32 s97, s31, 0
    s_mov_b32 s98, 10485760
    s_mov_b32 s99, 0x20000
    s_mov_b32 s60, 0
    s_mov_b32 s93, 0
    s_and_b32 s6, s6, 1
    s_barrier
    s_barrier
    s_barrier
    s_barrier
    s_waitcnt vmcnt(0)
    s_branch p1_wm
p1_wo:
    v_lshlrev_b32 v8, 4, v2
    v_add_u32 v9, 0x1000, v8
    global_load_dwordx4 v[76:79], v8, s[22:23] offset:0
    global_load_dwordx4 v[80:83], v8, s[22:23] offset:1024
    global_load_dwordx4 v[84:87], v8, s[22:23] offset:2048
    global_load_dwordx4 v[88:91], v8, s[22:23] offset:3072
    global_load_dwordx4 v[92:95], v9, s[22:23] offset:0
    global_load_dwordx4 v[96:99], v9, s[22:23] offset:1024
    global_load_dwordx4 v[100:103], v9, s[22:23] offset:2048
    global_load_dwordx4 v[104:107], v9, s[22:23] offset:3072
    s_add_u32 s30, s30, 0x1fffff
    s_addc_u32 s31, s31, 0
    s_and_b32 s30, s30, 0xffe00000
    s_mov_b32 s36, s30
    s_mov_b32 s37, s31
    s_mov_b32 s38, 10485760
    s_mov_b32 s39, 0x20000
    s_add_u32 s40, s30, 88080384
    s_addc_u32 s41, s31, 0
    s_mov_b32 s42, 10485760
    s_mov_b32 s43, 0x20000
    s_getreg_b32 s7, hwreg(HW_REG_XCC_ID, 0, 4)
    s_lshr_b32 s6, s7, 2
    s_mov_b64 s[56:57], 0
    s_mov_b32 s44, s8
    s_mov_b32 s45, s9
    s_mov_b32 s46, 6400000
    s_mov_b32 s47, 0x20000
    s_add_u32 s96, s30, 62914560
    s_addc_u32 s97, s31, 0
    s_mov_b32 s98, 10485760
    s_mov_b32 s99, 0x20000
    s_mov_b32 s60, 0
    s_mov_b32 s93, 0
    s_and_b32 s6, s6, 1
    v_add_u32 v8, 85632, v8
    v_bfe_u32 v9, v0, 2, 2
    v_lshl_add_u32 v9, v4, 3, v9
    v_lshlrev_b32 v9, 7, v9
    v_lshl_add_u32 v9, v6, 4, v9
    v_add_u32 v9, 85632, v9
    s_barrier
    s_barrier
    s_barrier
    s_barrier
    s_waitcnt vmcnt(0)
    ds_write_b128 v8, v[76:79] offset:0
    ds_write_b128 v8, v[80:83] offset:1024
    ds_write_b128 v8, v[84:87] offset:2048
    ds_write_b128 v8, v[88:91] offset:3072
    ds_write_b128 v8, v[92:95] offset:4096
    ds_write_b128 v8, v[96:99] offset:5120
    ds_write_b128 v8, v[100:103] offset:6144
    ds_write_b128 v8, v[104:107] offset:7168
    s_waitcnt lgkmcnt(0)
    ds_read_b64_tr_b16 v[44:45], v9 offset:0
    ds_read_b64_tr_b16 v[46:47], v9 offset:512
    ds_read_b64_tr_b16 v[48:49], v9 offset:4096
    ds_read_b64_tr_b16 v[50:51], v9 offset:4608
    ds_read_b64_tr_b16 v[52:53], v9 offset:8
    ds_read_b64_tr_b16 v[54:55], v9 offset:520
    ds_read_b64_tr_b16 v[56:57], v9 offset:4104
    ds_read_b64_tr_b16 v[58:59], v9 offset:4616
    ds_read_b64_tr_b16 v[60:61], v9 offset:64
    ds_read_b64_tr_b16 v[62:63], v9 offset:576
    ds_read_b64_tr_b16 v[64:65], v9 offset:4160
    ds_read_b64_tr_b16 v[66:67], v9 offset:4672
    s_waitcnt lgkmcnt(8)
    ds_read_b64_tr_b16 v[68:69], v9 offset:72
    ds_read_b64_tr_b16 v[70:71], v9 offset:584
    ds_read_b64_tr_b16 v[72:73], v9 offset:4168
    ds_read_b64_tr_b16 v[74:75], v9 offset:4680
    s_waitcnt lgkmcnt(0)
p1_wm:
    v_mfma_f32_16x16x32_bf16 v[76:79], v[12:15], v[44:47], 0
    v_mfma_f32_16x16x32_bf16 v[80:83], v[20:23], v[44:47], 0
    v_mfma_f32_16x16x32_bf16 v[84:87], v[28:31], v[44:47], 0
    v_mfma_f32_16x16x32_bf16 v[88:91], v[36:39], v[44:47], 0
    v_mfma_f32_16x16x32_bf16 v[76:79], v[16:19], v[48:51], v[76:79]
    v_mfma_f32_16x16x32_bf16 v[80:83], v[24:27], v[48:51], v[80:83]
    v_mfma_f32_16x16x32_bf16 v[84:87], v[32:35], v[48:51], v[84:87]
    v_mfma_f32_16x16x32_bf16 v[88:91], v[40:43], v[48:51], v[88:91]
    v_mfma_f32_16x16x32_bf16 v[92:95], v[12:15], v[52:55], 0
    v_mfma_f32_16x16x32_bf16 v[96:99], v[20:23], v[52:55], 0
    v_mfma_f32_16x16x32_bf16 v[100:103], v[28:31], v[52:55], 0
    v_mfma_f32_16x16x32_bf16 v[104:107], v[36:39], v[52:55], 0
    v_mfma_f32_16x16x32_bf16 v[92:95], v[16:19], v[56:59], v[92:95]
    v_mfma_f32_16x16x32_bf16 v[96:99], v[24:27], v[56:59], v[96:99]
    v_mfma_f32_16x16x32_bf16 v[100:103], v[32:35], v[56:59], v[100:103]
    v_mfma_f32_16x16x32_bf16 v[104:107], v[40:43], v[56:59], v[104:107]
    v_mfma_f32_16x16x32_bf16 v[108:111], v[12:15], v[60:63], 0
    v_mfma_f32_16x16x32_bf16 v[112:115], v[20:23], v[60:63], 0
    v_mfma_f32_16x16x32_bf16 v[116:119], v[28:31], v[60:63], 0
    v_mfma_f32_16x16x32_bf16 v[120:123], v[36:39], v[60:63], 0
    v_mfma_f32_16x16x32_bf16 v[108:111], v[16:19], v[64:67], v[108:111]
    v_mfma_f32_16x16x32_bf16 v[112:115], v[24:27], v[64:67], v[112:115]
    v_mfma_f32_16x16x32_bf16 v[116:119], v[32:35], v[64:67], v[116:119]
    v_mfma_f32_16x16x32_bf16 v[120:123], v[40:43], v[64:67], v[120:123]
    v_mfma_f32_16x16x32_bf16 v[44:47], v[12:15], v[68:71], 0
    v_mfma_f32_16x16x32_bf16 v[48:51], v[20:23], v[68:71], 0
    v_mfma_f32_16x16x32_bf16 v[52:55], v[28:31], v[68:71], 0
    v_mfma_f32_16x16x32_bf16 v[56:59], v[36:39], v[68:71], 0
    v_mfma_f32_16x16x32_bf16 v[44:47], v[16:19], v[72:75], v[44:47]
    v_mfma_f32_16x16x32_bf16 v[48:51], v[24:27], v[72:75], v[48:51]
    v_mfma_f32_16x16x32_bf16 v[52:55], v[32:35], v[72:75], v[52:55]
    v_mfma_f32_16x16x32_bf16 v[56:59], v[40:43], v[72:75], v[56:59]
    s_nop 7
    v_pk_add_f32 v[20:21], v[76:77], v[78:79]
    v_pk_add_f32 v[22:23], v[92:93], v[94:95]
    v_pk_add_f32 v[24:25], v[108:109], v[110:111]
    v_pk_add_f32 v[26:27], v[44:45], v[46:47]
    v_pk_add_f32 v[20:21], v[20:21], v[80:81]
    v_pk_add_f32 v[22:23], v[22:23], v[96:97]
    v_pk_add_f32 v[24:25], v[24:25], v[112:113]
    v_pk_add_f32 v[26:27], v[26:27], v[48:49]
    v_pk_add_f32 v[20:21], v[20:21], v[82:83]
    v_pk_add_f32 v[22:23], v[22:23], v[98:99]
    v_pk_add_f32 v[24:25], v[24:25], v[114:115]
    v_pk_add_f32 v[26:27], v[26:27], v[50:51]
    v_pk_add_f32 v[20:21], v[20:21], v[84:85]
    v_pk_add_f32 v[22:23], v[22:23], v[100:101]
    v_pk_add_f32 v[24:25], v[24:25], v[116:117]
    v_pk_add_f32 v[26:27], v[26:27], v[52:53]
    v_pk_add_f32 v[20:21], v[20:21], v[86:87]
    v_pk_add_f32 v[22:23], v[22:23], v[102:103]
    v_pk_add_f32 v[24:25], v[24:25], v[118:119]
    v_pk_add_f32 v[26:27], v[26:27], v[54:55]
    v_pk_add_f32 v[20:21], v[20:21], v[88:89]
    v_pk_add_f32 v[22:23], v[22:23], v[104:105]
    v_pk_add_f32 v[24:25], v[24:25], v[120:121]
    v_pk_add_f32 v[26:27], v[26:27], v[56:57]
    v_pk_add_f32 v[20:21], v[20:21], v[90:91]
    v_pk_add_f32 v[22:23], v[22:23], v[106:107]
    v_pk_add_f32 v[24:25], v[24:25], v[122:123]
    v_pk_add_f32 v[26:27], v[26:27], v[58:59]
    v_add_f32 v12, v20, v21
    v_add_f32 v13, v22, v23
    v_add_f32 v14, v24, v25
    v_add_f32 v15, v26, v27
    v_mov_b32 v16, v12
    v_mov_b32 v17, v13
    v_mov_b32 v18, v14
    v_mov_b32 v19, v15
    s_nop 1
    v_permlane16_swap_b32 v12, v16
    v_permlane16_swap_b32 v13, v17
    v_permlane16_swap_b32 v14, v18
    v_permlane16_swap_b32 v15, v19
    v_add_f32 v12, v12, v16
    v_add_f32 v13, v13, v17
    v_add_f32 v14, v14, v18
    v_add_f32 v15, v15, v19
    v_mov_b32 v16, v12
    v_mov_b32 v17, v13
    v_mov_b32 v18, v14
    v_mov_b32 v19, v15
    s_nop 1
    v_permlane32_swap_b32 v12, v16
    v_permlane32_swap_b32 v13, v17
    v_permlane32_swap_b32 v14, v18
    v_permlane32_swap_b32 v15, v19
    v_add_f32 v12, v12, v16
    v_add_f32 v13, v13, v17
    v_add_f32 v14, v14, v18
    v_add_f32 v15, v15, v19
    v_mul_f32 v20, 0xbc800000, v12
    v_mul_f32 v22, 0xbc800000, v13
    v_mul_f32 v24, 0xbc800000, v14
    v_mul_f32 v26, 0xbc800000, v15
    s_cmp_eq_u32 s4, 14
    s_cbranch_scc0 p1_wc
    v_pk_add_f32 v[28:29], v[76:77], v[92:93]
    v_pk_add_f32 v[30:31], v[78:79], v[94:95]
    v_pk_add_f32 v[32:33], v[80:81], v[96:97]
    v_pk_add_f32 v[34:35], v[82:83], v[98:99]
    v_pk_add_f32 v[36:37], v[84:85], v[100:101]
    v_pk_add_f32 v[38:39], v[86:87], v[102:103]
    v_pk_add_f32 v[40:41], v[88:89], v[104:105]
    v_pk_add_f32 v[42:43], v[90:91], v[106:107]
    v_pk_add_f32 v[28:29], v[28:29], v[108:109]
    v_pk_add_f32 v[30:31], v[30:31], v[110:111]
    v_pk_add_f32 v[32:33], v[32:33], v[112:113]
    v_pk_add_f32 v[34:35], v[34:35], v[114:115]
    v_pk_add_f32 v[36:37], v[36:37], v[116:117]
    v_pk_add_f32 v[38:39], v[38:39], v[118:119]
    v_pk_add_f32 v[40:41], v[40:41], v[120:121]
    v_pk_add_f32 v[42:43], v[42:43], v[122:123]
    v_pk_add_f32 v[28:29], v[28:29], v[44:45]
    v_pk_add_f32 v[30:31], v[30:31], v[46:47]
    v_pk_add_f32 v[32:33], v[32:33], v[48:49]
    v_pk_add_f32 v[34:35], v[34:35], v[50:51]
    v_pk_add_f32 v[36:37], v[36:37], v[52:53]
    v_pk_add_f32 v[38:39], v[38:39], v[54:55]
    v_pk_add_f32 v[40:41], v[40:41], v[56:57]
    v_pk_add_f32 v[42:43], v[42:43], v[58:59]
    v_add_f32 v12, v20, v22
    v_add_f32 v13, v24, v26
    v_add_f32 v12, v12, v13
    s_nop 1
    v_add_f32_dpp v12, v12, v12 quad_perm:[1,0,3,2] row_mask:0xf bank_mask:0xf
    v_add_f32_dpp v28, v28, v28 quad_perm:[1,0,3,2] row_mask:0xf bank_mask:0xf
    v_add_f32_dpp v29, v29, v29 quad_perm:[1,0,3,2] row_mask:0xf bank_mask:0xf
    v_add_f32_dpp v30, v30, v30 quad_perm:[1,0,3,2] row_mask:0xf bank_mask:0xf
    v_add_f32_dpp v31, v31, v31 quad_perm:[1,0,3,2] row_mask:0xf bank_mask:0xf
    v_add_f32_dpp v32, v32, v32 quad_perm:[1,0,3,2] row_mask:0xf bank_mask:0xf
    v_add_f32_dpp v33, v33, v33 quad_perm:[1,0,3,2] row_mask:0xf bank_mask:0xf
    v_add_f32_dpp v34, v34, v34 quad_perm:[1,0,3,2] row_mask:0xf bank_mask:0xf
    v_add_f32_dpp v35, v35, v35 quad_perm:[1,0,3,2] row_mask:0xf bank_mask:0xf
    v_add_f32_dpp v36, v36, v36 quad_perm:[1,0,3,2] row_mask:0xf bank_mask:0xf
    v_add_f32_dpp v37, v37, v37 quad_perm:[1,0,3,2] row_mask:0xf bank_mask:0xf
    v_add_f32_dpp v38, v38, v38 quad_perm:[1,0,3,2] row_mask:0xf bank_mask:0xf
    v_add_f32_dpp v39, v39, v39 quad_perm:[1,0,3,2] row_mask:0xf bank_mask:0xf
    v_add_f32_dpp v40, v40, v40 quad_perm:[1,0,3,2] row_mask:0xf bank_mask:0xf
    v_add_f32_dpp v41, v41, v41 quad_perm:[1,0,3,2] row_mask:0xf bank_mask:0xf
    v_add_f32_dpp v42, v42, v42 quad_perm:[1,0,3,2] row_mask:0xf bank_mask:0xf
    v_add_f32_dpp v43, v43, v43 quad_perm:[1,0,3,2] row_mask:0xf bank_mask:0xf
    v_add_f32_dpp v12, v12, v12 quad_perm:[2,3,0,1] row_mask:0xf bank_mask:0xf
    v_add_f32_dpp v28, v28, v28 quad_perm:[2,3,0,1] row_mask:0xf bank_mask:0xf
    v_add_f32_dpp v29, v29, v29 quad_perm:[2,3,0,1] row_mask:0xf bank_mask:0xf
    v_add_f32_dpp v30, v30, v30 quad_perm:[2,3,0,1] row_mask:0xf bank_mask:0xf
    v_add_f32_dpp v31, v31, v31 quad_perm:[2,3,0,1] row_mask:0xf bank_mask:0xf
    v_add_f32_dpp v32, v32, v32 quad_perm:[2,3,0,1] row_mask:0xf bank_mask:0xf
    v_add_f32_dpp v33, v33, v33 quad_perm:[2,3,0,1] row_mask:0xf bank_mask:0xf
    v_add_f32_dpp v34, v34, v34 quad_perm:[2,3,0,1] row_mask:0xf bank_mask:0xf
    v_add_f32_dpp v35, v35, v35 quad_perm:[2,3,0,1] row_mask:0xf bank_mask:0xf
    v_add_f32_dpp v36, v36, v36 quad_perm:[2,3,0,1] row_mask:0xf bank_mask:0xf
    v_add_f32_dpp v37, v37, v37 quad_perm:[2,3,0,1] row_mask:0xf bank_mask:0xf
    v_add_f32_dpp v38, v38, v38 quad_perm:[2,3,0,1] row_mask:0xf bank_mask:0xf
    v_add_f32_dpp v39, v39, v39 quad_perm:[2,3,0,1] row_mask:0xf bank_mask:0xf
    v_add_f32_dpp v40, v40, v40 quad_perm:[2,3,0,1] row_mask:0xf bank_mask:0xf
    v_add_f32_dpp v41, v41, v41 quad_perm:[2,3,0,1] row_mask:0xf bank_mask:0xf
    v_add_f32_dpp v42, v42, v42 quad_perm:[2,3,0,1] row_mask:0xf bank_mask:0xf
    v_add_f32_dpp v43, v43, v43 quad_perm:[2,3,0,1] row_mask:0xf bank_mask:0xf
    v_add_f32_dpp v12, v12, v12 row_half_mirror row_mask:0xf bank_mask:0xf
    v_add_f32_dpp v28, v28, v28 row_half_mirror row_mask:0xf bank_mask:0xf
    v_add_f32_dpp v29, v29, v29 row_half_mirror row_mask:0xf bank_mask:0xf
    v_add_f32_dpp v30, v30, v30 row_half_mirror row_mask:0xf bank_mask:0xf
    v_add_f32_dpp v31, v31, v31 row_half_mirror row_mask:0xf bank_mask:0xf
    v_add_f32_dpp v32, v32, v32 row_half_mirror row_mask:0xf bank_mask:0xf
    v_add_f32_dpp v33, v33, v33 row_half_mirror row_mask:0xf bank_mask:0xf
    v_add_f32_dpp v34, v34, v34 row_half_mirror row_mask:0xf bank_mask:0xf
    v_add_f32_dpp v35, v35, v35 row_half_mirror row_mask:0xf bank_mask:0xf
    v_add_f32_dpp v36, v36, v36 row_half_mirror row_mask:0xf bank_mask:0xf
    v_add_f32_dpp v37, v37, v37 row_half_mirror row_mask:0xf bank_mask:0xf
    v_add_f32_dpp v38, v38, v38 row_half_mirror row_mask:0xf bank_mask:0xf
    v_add_f32_dpp v39, v39, v39 row_half_mirror row_mask:0xf bank_mask:0xf
    v_add_f32_dpp v40, v40, v40 row_half_mirror row_mask:0xf bank_mask:0xf
    v_add_f32_dpp v41, v41, v41 row_half_mirror row_mask:0xf bank_mask:0xf
    v_add_f32_dpp v42, v42, v42 row_half_mirror row_mask:0xf bank_mask:0xf
    v_add_f32_dpp v43, v43, v43 row_half_mirror row_mask:0xf bank_mask:0xf
    v_add_f32_dpp v12, v12, v12 row_mirror row_mask:0xf bank_mask:0xf
    v_add_f32_dpp v28, v28, v28 row_mirror row_mask:0xf bank_mask:0xf
    v_add_f32_dpp v29, v29, v29 row_mirror row_mask:0xf bank_mask:0xf
    v_add_f32_dpp v30, v30, v30 row_mirror row_mask:0xf bank_mask:0xf
    v_add_f32_dpp v31, v31, v31 row_mirror row_mask:0xf bank_mask:0xf
    v_add_f32_dpp v32, v32, v32 row_mirror row_mask:0xf bank_mask:0xf
    v_add_f32_dpp v33, v33, v33 row_mirror row_mask:0xf bank_mask:0xf
    v_add_f32_dpp v34, v34, v34 row_mirror row_mask:0xf bank_mask:0xf
    v_add_f32_dpp v35, v35, v35 row_mirror row_mask:0xf bank_mask:0xf
    v_add_f32_dpp v36, v36, v36 row_mirror row_mask:0xf bank_mask:0xf
    v_add_f32_dpp v37, v37, v37 row_mirror row_mask:0xf bank_mask:0xf
    v_add_f32_dpp v38, v38, v38 row_mirror row_mask:0xf bank_mask:0xf
    v_add_f32_dpp v39, v39, v39 row_mirror row_mask:0xf bank_mask:0xf
    v_add_f32_dpp v40, v40, v40 row_mirror row_mask:0xf bank_mask:0xf
    v_add_f32_dpp v41, v41, v41 row_mirror row_mask:0xf bank_mask:0xf
    v_add_f32_dpp v42, v42, v42 row_mirror row_mask:0xf bank_mask:0xf
    v_add_f32_dpp v43, v43, v43 row_mirror row_mask:0xf bank_mask:0xf
    v_mul_f32 v12, 0xbc800000, v12
    v_mov_b32 v14, 0xbc800000
    v_add_f32 v20, v20, v12
    v_add_f32 v22, v22, v12
    v_add_f32 v24, v24, v12
    v_add_f32 v26, v26, v12
    v_pk_fma_f32 v[76:77], v[28:29], v[14:15], v[76:77] op_sel_hi:[1,0,1]
    v_pk_fma_f32 v[78:79], v[30:31], v[14:15], v[78:79] op_sel_hi:[1,0,1]
    v_pk_fma_f32 v[80:81], v[32:33], v[14:15], v[80:81] op_sel_hi:[1,0,1]
    v_pk_fma_f32 v[82:83], v[34:35], v[14:15], v[82:83] op_sel_hi:[1,0,1]
    v_pk_fma_f32 v[84:85], v[36:37], v[14:15], v[84:85] op_sel_hi:[1,0,1]
    v_pk_fma_f32 v[86:87], v[38:39], v[14:15], v[86:87] op_sel_hi:[1,0,1]
    v_pk_fma_f32 v[88:89], v[40:41], v[14:15], v[88:89] op_sel_hi:[1,0,1]
    v_pk_fma_f32 v[90:91], v[42:43], v[14:15], v[90:91] op_sel_hi:[1,0,1]
    v_pk_fma_f32 v[92:93], v[28:29], v[14:15], v[92:93] op_sel_hi:[1,0,1]
    v_pk_fma_f32 v[94:95], v[30:31], v[14:15], v[94:95] op_sel_hi:[1,0,1]
    v_pk_fma_f32 v[96:97], v[32:33], v[14:15], v[96:97] op_sel_hi:[1,0,1]
    v_pk_fma_f32 v[98:99], v[34:35], v[14:15], v[98:99] op_sel_hi:[1,0,1]
    v_pk_fma_f32 v[100:101], v[36:37], v[14:15], v[100:101] op_sel_hi:[1,0,1]
    v_pk_fma_f32 v[102:103], v[38:39], v[14:15], v[102:103] op_sel_hi:[1,0,1]
    v_pk_fma_f32 v[104:105], v[40:41], v[14:15], v[104:105] op_sel_hi:[1,0,1]
    v_pk_fma_f32 v[106:107], v[42:43], v[14:15], v[106:107] op_sel_hi:[1,0,1]
    v_pk_fma_f32 v[108:109], v[28:29], v[14:15], v[108:109] op_sel_hi:[1,0,1]
    v_pk_fma_f32 v[110:111], v[30:31], v[14:15], v[110:111] op_sel_hi:[1,0,1]
    v_pk_fma_f32 v[112:113], v[32:33], v[14:15], v[112:113] op_sel_hi:[1,0,1]
    v_pk_fma_f32 v[114:115], v[34:35], v[14:15], v[114:115] op_sel_hi:[1,0,1]
    v_pk_fma_f32 v[116:117], v[36:37], v[14:15], v[116:117] op_sel_hi:[1,0,1]
    v_pk_fma_f32 v[118:119], v[38:39], v[14:15], v[118:119] op_sel_hi:[1,0,1]
    v_pk_fma_f32 v[120:121], v[40:41], v[14:15], v[120:121] op_sel_hi:[1,0,1]
    v_pk_fma_f32 v[122:123], v[42:43], v[14:15], v[122:123] op_sel_hi:[1,0,1]
    v_pk_fma_f32 v[44:45], v[28:29], v[14:15], v[44:45] op_sel_hi:[1,0,1]
    v_pk_fma_f32 v[46:47], v[30:31], v[14:15], v[46:47] op_sel_hi:[1,0,1]
    v_pk_fma_f32 v[48:49], v[32:33], v[14:15], v[48:49] op_sel_hi:[1,0,1]
    v_pk_fma_f32 v[50:51], v[34:35], v[14:15], v[50:51] op_sel_hi:[1,0,1]
    v_pk_fma_f32 v[52:53], v[36:37], v[14:15], v[52:53] op_sel_hi:[1,0,1]
    v_pk_fma_f32 v[54:55], v[38:39], v[14:15], v[54:55] op_sel_hi:[1,0,1]
    v_pk_fma_f32 v[56:57], v[40:41], v[14:15], v[56:57] op_sel_hi:[1,0,1]
    v_pk_fma_f32 v[58:59], v[42:43], v[14:15], v[58:59] op_sel_hi:[1,0,1]
p1_wc:
    s_sub_u32 s64, 14, s4
    s_lshl_b32 s64, s64, 13
    s_add_u32 s64, s64, 110784
    v_lshlrev_b32 v8, 4, v2
    v_add_u32 v8, s64, v8
    v_pk_add_f32 v[76:77], v[76:77], v[20:21] op_sel_hi:[1,0]
    v_pk_add_f32 v[78:79], v[78:79], v[20:21] op_sel_hi:[1,0]
    v_pk_add_f32 v[80:81], v[80:81], v[20:21] op_sel_hi:[1,0]
    v_pk_add_f32 v[82:83], v[82:83], v[20:21] op_sel_hi:[1,0]
    v_pk_add_f32 v[84:85], v[84:85], v[20:21] op_sel_hi:[1,0]
    v_pk_add_f32 v[86:87], v[86:87], v[20:21] op_sel_hi:[1,0]
    v_pk_add_f32 v[88:89], v[88:89], v[20:21] op_sel_hi:[1,0]
    v_pk_add_f32 v[90:91], v[90:91], v[20:21] op_sel_hi:[1,0]
    v_cvt_pk_bf16_f32 v76, v76, v77
    v_cvt_pk_bf16_f32 v77, v78, v79
    v_cvt_pk_bf16_f32 v78, v80, v81
    v_cvt_pk_bf16_f32 v79, v82, v83
    ds_write_b128 v8, v[76:79] offset:0
    v_cvt_pk_bf16_f32 v84, v84, v85
    v_cvt_pk_bf16_f32 v85, v86, v87
    v_cvt_pk_bf16_f32 v86, v88, v89
    v_cvt_pk_bf16_f32 v87, v90, v91
    ds_write_b128 v8, v[84:87] offset:1024
    v_pk_add_f32 v[92:93], v[92:93], v[22:23] op_sel_hi:[1,0]
    v_pk_add_f32 v[94:95], v[94:95], v[22:23] op_sel_hi:[1,0]
    v_pk_add_f32 v[96:97], v[96:97], v[22:23] op_sel_hi:[1,0]
    v_pk_add_f32 v[98:99], v[98:99], v[22:23] op_sel_hi:[1,0]
    v_pk_add_f32 v[100:101], v[100:101], v[22:23] op_sel_hi:[1,0]
    v_pk_add_f32 v[102:103], v[102:103], v[22:23] op_sel_hi:[1,0]
    v_pk_add_f32 v[104:105], v[104:105], v[22:23] op_sel_hi:[1,0]
    v_pk_add_f32 v[106:107], v[106:107], v[22:23] op_sel_hi:[1,0]
    v_cvt_pk_bf16_f32 v92, v92, v93
    v_cvt_pk_bf16_f32 v93, v94, v95
    v_cvt_pk_bf16_f32 v94, v96, v97
    v_cvt_pk_bf16_f32 v95, v98, v99
    ds_write_b128 v8, v[92:95] offset:2048
    v_cvt_pk_bf16_f32 v100, v100, v101
    v_cvt_pk_bf16_f32 v101, v102, v103
    v_cvt_pk_bf16_f32 v102, v104, v105
    v_cvt_pk_bf16_f32 v103, v106, v107
    ds_write_b128 v8, v[100:103] offset:3072
    v_pk_add_f32 v[108:109], v[108:109], v[24:25] op_sel_hi:[1,0]
    v_pk_add_f32 v[110:111], v[110:111], v[24:25] op_sel_hi:[1,0]
    v_pk_add_f32 v[112:113], v[112:113], v[24:25] op_sel_hi:[1,0]
    v_pk_add_f32 v[114:115], v[114:115], v[24:25] op_sel_hi:[1,0]
    v_pk_add_f32 v[116:117], v[116:117], v[24:25] op_sel_hi:[1,0]
    v_pk_add_f32 v[118:119], v[118:119], v[24:25] op_sel_hi:[1,0]
    v_pk_add_f32 v[120:121], v[120:121], v[24:25] op_sel_hi:[1,0]
    v_pk_add_f32 v[122:123], v[122:123], v[24:25] op_sel_hi:[1,0]
    v_cvt_pk_bf16_f32 v108, v108, v109
    v_cvt_pk_bf16_f32 v109, v110, v111
    v_cvt_pk_bf16_f32 v110, v112, v113
    v_cvt_pk_bf16_f32 v111, v114, v115
    ds_write_b128 v8, v[108:111] offset:4096
    v_cvt_pk_bf16_f32 v116, v116, v117
    v_cvt_pk_bf16_f32 v117, v118, v119
    v_cvt_pk_bf16_f32 v118, v120, v121
    v_cvt_pk_bf16_f32 v119, v122, v123
    ds_write_b128 v8, v[116:119] offset:5120
    v_pk_add_f32 v[44:45], v[44:45], v[26:27] op_sel_hi:[1,0]
    v_pk_add_f32 v[46:47], v[46:47], v[26:27] op_sel_hi:[1,0]
    v_pk_add_f32 v[48:49], v[48:49], v[26:27] op_sel_hi:[1,0]
    v_pk_add_f32 v[50:51], v[50:51], v[26:27] op_sel_hi:[1,0]
    v_pk_add_f32 v[52:53], v[52:53], v[26:27] op_sel_hi:[1,0]
    v_pk_add_f32 v[54:55], v[54:55], v[26:27] op_sel_hi:[1,0]
    v_pk_add_f32 v[56:57], v[56:57], v[26:27] op_sel_hi:[1,0]
    v_pk_add_f32 v[58:59], v[58:59], v[26:27] op_sel_hi:[1,0]
    v_cvt_pk_bf16_f32 v44, v44, v45
    v_cvt_pk_bf16_f32 v45, v46, v47
    v_cvt_pk_bf16_f32 v46, v48, v49
    v_cvt_pk_bf16_f32 v47, v50, v51
    ds_write_b128 v8, v[44:47] offset:6144
    v_cvt_pk_bf16_f32 v52, v52, v53
    v_cvt_pk_bf16_f32 v53, v54, v55
    v_cvt_pk_bf16_f32 v54, v56, v57
    v_cvt_pk_bf16_f32 v55, v58, v59
    ds_write_b128 v8, v[52:55] offset:7168
    s_branch p1_done
p1_probe:
    s_add_u32 s30, s30, 0x1fffff
    s_addc_u32 s31, s31, 0
    s_and_b32 s30, s30, 0xffe00000
    s_mov_b32 s36, s30
    s_mov_b32 s37, s31
    s_mov_b32 s38, 10485760
    s_mov_b32 s39, 0x20000
    s_add_u32 s40, s30, 88080384
    s_addc_u32 s41, s31, 0
    s_mov_b32 s42, 10485760
    s_mov_b32 s43, 0x20000
    s_getreg_b32 s7, hwreg(HW_REG_XCC_ID, 0, 4)
    s_lshr_b32 s6, s7, 2
    s_mov_b64 s[56:57], 0
    s_mov_b32 s44, s8
    s_mov_b32 s45, s9
    s_mov_b32 s46, 6400000
    s_mov_b32 s47, 0x20000
    s_add_u32 s96, s30, 62914560
    s_addc_u32 s97, s31, 0
    s_mov_b32 s98, 10485760
    s_mov_b32 s99, 0x20000
    s_mov_b32 s60, 0
    s_mov_b32 s93, 0
    s_and_b32 s6, s6, 1
    s_and_b32 s64, s2, 3
    s_and_b32 s74, s2, 1
    s_lshl_b32 s64, s64, 21
    s_lshr_b32 s65, s2, 2
    s_lshl_b32 s65, s65, 7
    s_add_u32 s64, s64, s65
    s_add_u32 s64, s64, 2080768
    v_mov_b32 v40, s64
    v_add_u32 v41, 0x2000, v40
    v_mov_b32 v42, 0
    v_mov_b32 v76, -1
    v_mov_b32 v77, -1
    v_mov_b32 v78, -1
    v_mov_b32 v79, -1
    v_cmp_gt_u32 vcc, 7, v2
    v_add_u32 v45, 35, v2
    v_cmp_eq_u32 s[66:67], 7, v2
    v_cndmask_b32 v45, v45, v2, vcc
    v_cmp_eq_u32 vcc, 10, v2
    v_mov_b32 v46, 0x1fff80
    v_cndmask_b32 v46, v46, 0, s[66:67]
    v_cndmask_b32 v45, v45, 47, vcc
    v_lshl_add_u32 v45, v45, 21, v46
    s_mov_b64 exec, 1
    global_atomic_add v43, v40, v42, s[30:31] sc0 sc1
    global_atomic_add v44, v41, v42, s[30:31] sc0 sc1
    s_mov_b32 s63, 0
    s_mov_b32 s62, 1
    s_and_b32 s64, s2, 7
    s_lshr_b32 s65, s64, 2
    s_xor_b32 s65, s65, s63
    s_lshl_b32 s65, s65, 13
    s_lshl_b32 s64, s64, 8
    s_add_u32 s64, s64, s65
    s_add_u32 s56, s64, 98582528
    s_xor_b32 s65, s6, s63
    s_lshl_b32 s65, s65, 13
    s_and_b32 s64, s7, 7
    s_lshl_b32 s64, s64, 8
    s_add_u32 s64, s64, s65
    s_mov_b32 s75, 98586624
    s_add_u32 s57, s64, s75
    s_barrier
    s_barrier
    s_barrier
    global_load_dword v58, v42, s[28:29] sc1
    s_barrier
    s_mov_b32 s67, 0
    s_waitcnt vmcnt(0)
    s_mov_b32 s64, 0
    s_barrier
gb0_i:
    v_readfirstlane_b32 s65, v58
    s_cmp_lg_u32 s65, 0
    s_cbranch_scc1 gb0_id
    s_sleep 2
    global_load_dword v58, v42, s[28:29] sc1
    s_add_u32 s64, s64, 1
    s_cmp_lt_u32 s64, 0x400000
    s_waitcnt vmcnt(0)
    s_cbranch_scc1 gb0_i
gb0_id:
    v_mov_b32 v56, s56
    v_mov_b32 v57, 1
    global_atomic_add v58, v56, v57, s[30:31] sc0 sc1
    s_lshl_b32 s64, s62, 5
    s_sub_u32 s64, s64, 1
    v_mov_b32 v56, s57
    s_waitcnt vmcnt(0)
    v_readfirstlane_b32 s65, v58
    s_cmp_lg_u32 s65, s64
    s_cbranch_scc1 gb0_np
    s_mov_b32 s65, 1
    s_mov_b64 exec, 0xff
    v_mbcnt_lo_u32_b32 v58, -1, 0
    v_lshrrev_b32 v59, 2, v58
    v_xor_b32 v59, s63, v59
    v_lshlrev_b32 v59, 13, v59
    v_lshl_add_u32 v58, v58, 8, v59
    v_add_u32 v58, s75, v58
    v_mov_b32 v57, s65
    global_atomic_add v58, v57, s[30:31] sc1
    s_mov_b64 exec, 1
gb0_np:
    s_mov_b32 s72, 0
p1_pm:
    global_atomic_add v43, v40, v42, s[30:31] sc0 sc1
    global_atomic_add v44, v41, v42, s[30:31] sc0 sc1
    s_waitcnt vmcnt(1)
    s_memtime s[68:69]
    s_waitcnt vmcnt(0)
    s_memtime s[70:71]
    v_swap_b32 v40, v41
    s_waitcnt lgkmcnt(0)
    s_sub_u32 s66, s70, s68
    s_sub_u32 s67, s66, s67
    s_add_u32 s72, s72, 1
    s_cmp_lt_u32 s72, 2
    s_cbranch_scc1 p1_pm
    s_cmp_gt_i32 s67, 0
    s_cselect_b32 s65, 1, 0
    s_xor_b32 s65, s65, s6
    s_xor_b32 s65, s65, s74
    s_lshl_b32 s65, s65, 8
    s_or_b32 s93, s65, 1
    s_and_b32 s64, s2, 7
    s_lshr_b32 s65, s64, 2
    s_xor_b32 s65, s65, s63
    s_lshl_b32 s65, s65, 13
    s_lshl_b32 s64, s64, 8
    s_add_u32 s64, s64, s65
    s_add_u32 s56, s64, 98598912
    s_xor_b32 s65, s6, s63
    s_lshl_b32 s65, s65, 13
    s_and_b32 s64, s7, 7
    s_lshl_b32 s64, s64, 8
    s_add_u32 s64, s64, s65
    s_mov_b32 s75, 98603008
    s_add_u32 s57, s64, s75
    s_mov_b64 exec, -1
    v_lshrrev_b32 v2, 2, v0
    v_and_b32 v3, 3, v0
    v_lshlrev_b32 v70, 10, v2
    s_lshl_b32 s92, s5, 2
    s_add_u32 s92, s92, 4194304
    s_movk_i32 s65, 250
    v_cmp_gt_u32 s[48:49], s65, v2
    v_mov_b32 v72, 2147479552
    v_and_b32 v73, 63, v0
    v_lshlrev_b32 v8, 2, v73
    v_cndmask_b32 v70, v72, v70, s[48:49]
    v_mul_u32_u24 v71, 12800, v2
    v_lshl_add_u32 v71, v3, 4, v71
    v_add_u32 v71, 128, v71
    v_lshlrev_b32 v3, 2, v3
    v_mov_b32 v69, 4
    v_mov_b32 v21, 1
    s_mov_b64 exec, 1
    s_mov_b32 s64, 8
    s_mov_b32 s65, 0
gb0_p:
    global_load_dword v58, v56, s[30:31] sc1
    s_waitcnt vmcnt(0)
    v_cmp_gt_u32 vcc, s64, v58
    s_cbranch_vccz gb0_pd
    s_add_u32 s65, s65, 1
    s_cmp_lt_u32 s65, 0x800000
    s_cbranch_scc1 gb0_p
gb0_pd:
    s_mov_b64 exec, -1
    s_branch p1_d9
p1_done:
    v_lshrrev_b32 v2, 2, v0
    v_and_b32 v3, 3, v0
    v_lshlrev_b32 v70, 10, v2
    s_lshl_b32 s92, s5, 2
    s_add_u32 s92, s92, 4194304
    s_movk_i32 s65, 250
    v_cmp_gt_u32 s[48:49], s65, v2
    v_mov_b32 v72, 2147479552
    v_and_b32 v73, 63, v0
    v_lshlrev_b32 v8, 2, v73
    v_cndmask_b32 v70, v72, v70, s[48:49]
    v_mul_u32_u24 v71, 12800, v2
    v_lshl_add_u32 v71, v3, 4, v71
    v_add_u32 v71, 128, v71
    v_lshlrev_b32 v3, 2, v3
    v_mov_b32 v69, 4
    v_mov_b32 v21, 1
p1_d9:
    s_waitcnt vmcnt(0) lgkmcnt(0)
    s_barrier
    buffer_load_dword v5, v70, s[40:43], s92 offen sc1
    s_cmp_lg_u32 s4, 15
    s_cbranch_scc1 p2_na
    s_mov_b64 exec, 1
    v_mov_b32 v57, s93
    v_mov_b32 v56, s56
    global_atomic_add v58, v56, v57, s[30:31] sc0 sc1
    s_mov_b64 exec, -1
p2_na:
    s_waitcnt vmcnt(0)
    v_and_b32 v9, 0xffff, v5
    v_lshrrev_b32 v11, 16, v5
    v_lshl_add_u32 v4, v9, 2, v71
    v_cndmask_b32 v4, v72, v4, s[48:49]
    buffer_load_dwordx4 v[12:15], v4, s[40:43], 0 offen sc1
    buffer_load_dwordx4 v[16:19], v4, s[40:43], 0 offen offset:64 sc1
    v_sub_u32 v20, v11, v3
    v_mov_b32 v6, v72
    v_mov_b32 v7, v73
    s_cmp_lg_u32 s4, 15
    s_cbranch_scc1 p2_nw
    s_mov_b64 exec, 1
    v_add_u32 v57, v57, v58
    v_mov_b32 v56, s57
    v_readfirstlane_b32 s65, v57
    s_and_b32 s64, s65, 0xff
    s_cmp_lg_u32 s64, 32
    s_cbranch_scc1 gbb_np
    s_sub_u32 s65, s65, 31
    s_mov_b64 exec, 0xff
    v_mbcnt_lo_u32_b32 v58, -1, 0
    v_lshrrev_b32 v59, 2, v58
    v_xor_b32 v59, s63, v59
    v_lshlrev_b32 v59, 13, v59
    v_lshl_add_u32 v58, v58, 8, v59
    v_add_u32 v58, s75, v58
    v_mov_b32 v57, s65
    global_atomic_add v58, v57, s[30:31] sc1
    s_mov_b64 exec, 1
gbb_np:
    s_mov_b64 exec, -1
p2_nw:
    s_waitcnt vmcnt(0)
    v_and_b32 v80, 0x1ffc, v12
    v_and_b32 v81, 0x1ffc, v13
    v_and_b32 v82, 0x1ffc, v14
    v_and_b32 v83, 0x1ffc, v15
    v_and_b32 v84, 0x1ffc, v16
    v_and_b32 v85, 0x1ffc, v17
    v_and_b32 v86, 0x1ffc, v18
    v_and_b32 v87, 0x1ffc, v19
    v_cmpx_lt_i32 vcc, 0, v20
    ds_add_u32 v80, v21 offset:32896
    v_cmpx_lt_i32 vcc, 1, v20
    ds_add_u32 v81, v21 offset:32896
    v_cmpx_lt_i32 vcc, 2, v20
    ds_add_u32 v82, v21 offset:32896
    v_cmpx_lt_i32 vcc, 3, v20
    ds_add_u32 v83, v21 offset:32896
    v_cmpx_lt_i32 vcc, 16, v20
    ds_add_u32 v84, v21 offset:32896
    v_cmpx_lt_i32 vcc, 17, v20
    ds_add_u32 v85, v21 offset:32896
    v_cmpx_lt_i32 vcc, 18, v20
    ds_add_u32 v86, v21 offset:32896
    v_cmpx_lt_i32 vcc, 19, v20
    ds_add_u32 v87, v21 offset:32896
    s_mov_b64 exec, -1
    v_cmp_lt_i32 vcc, 32, v20
    s_cbranch_vccnz ls1
ls1_d:
    s_waitcnt lgkmcnt(0)
    s_barrier
    s_cmp_ge_u32 s4, 4
    s_cbranch_scc1 p2_n1
    v_add_u32 v36, s54, v0
    s_mov_b32 s64, 50000
    v_cmp_gt_u32 vcc, s64, v36
    s_movk_i32 s64, 196
    v_cmp_gt_u32 s[64:65], s64, v0
    s_and_b64 s[66:67], vcc, s[64:65]
    s_mov_b64 exec, s[66:67]
    v_lshlrev_b32 v37, 5, v0
    v_lshlrev_b32 v38, 3, v0
    ds_read_b128 v[40:43], v37 offset:32896
    ds_read_b128 v[44:47], v37 offset:32912
    ds_read_b64 v[58:59], v38 offset:26688
    v_lshrrev_b32 v62, 8, v36
    v_mul_u32_u24 v63, 205, v62
    v_lshl_add_u32 v66, v62, 7, v36
    v_lshrrev_b32 v63, 13, v63
    v_lshrrev_b32 v62, 1, v36
    v_lshl_add_u32 v66, v63, 10, v66
    v_bitop3_b32 v62, v62, v36, 64 bitop3:0x80
    v_add_u32 v66, v66, v62
    v_lshlrev_b32 v66, 7, v66
    v_and_b32 v62, 128, v36
    v_add_u32 v67, 0x2000, v66
    v_cmp_ne_u32 vcc, 0, v62
    v_mov_b32 v48, 0
    s_waitcnt lgkmcnt(1)
    v_cndmask_b32 v67, v6, v67, vcc
    v_mov_b32 v49, v40
    v_add_u32 v50, v49, v41
    v_add_u32 v51, v50, v42
    v_add_u32 v52, v51, v43
    v_add_u32 v53, v52, v44
    v_add_u32 v54, v53, v45
    v_add_u32 v55, v54, v46
    v_add_u32 v65, v55, v47
    v_min_u32 v57, 63, v65
    v_sub_u32 v57, 63, v57
    v_lshlrev_b32 v57, 2, v57
    ds_add_rtn_u32 v60, v57, v21 offset:26368
    s_mov_b64 exec, -1
p2_n1:
    s_cmp_lg_u32 s4, 15
    s_cbranch_scc1 p2_nq
    s_mov_b64 exec, 1
    v_mov_b32 v56, s57
    s_mov_b32 s64, 8
    s_mov_b32 s65, 0
gbb_p:
    global_load_dword v58, v56, s[30:31] sc1
    s_waitcnt vmcnt(0)
    v_and_b32 v59, 0xff, v58
    v_cmp_gt_u32 vcc, s64, v59
    s_cbranch_vccz gbb_pd
    s_add_u32 s65, s65, 1
    s_cmp_lt_u32 s65, 0x800000
    s_cbranch_scc1 gbb_p
gbb_pd:
    v_mov_b32 v62, 26624
    ds_write_b32 v62, v58 offset:8
    s_mov_b64 exec, -1
p2_nq:
    v_mov_b32 v62, 26624
    s_waitcnt lgkmcnt(0)
    s_barrier
    ds_read_b32 v63, v62 offset:8
    ds_read_b32 v61, v8 offset:26368
    s_waitcnt lgkmcnt(0)
    v_readfirstlane_b32 s60, v63
    s_cmp_ge_u32 s60, 0x8000
    s_cselect_b32 s61, 1, 0
    s_xor_b32 s58, s61, s6
    s_lshr_b32 s58, 0xaa, s58
    s_cmp_ge_u32 s4, 4
    s_cbranch_scc1 p2_n2
    v_mov_b32 v62, v61
    s_nop 1
    v_add_u32_dpp v62, v62, v62 row_shr:1 row_mask:0xf bank_mask:0xf bound_ctrl:0
    s_nop 1
    v_add_u32_dpp v62, v62, v62 row_shr:2 row_mask:0xf bank_mask:0xf bound_ctrl:0
    s_nop 1
    v_add_u32_dpp v62, v62, v62 row_shr:4 row_mask:0xf bank_mask:0xf bound_ctrl:0
    s_nop 1
    v_add_u32_dpp v62, v62, v62 row_shr:8 row_mask:0xf bank_mask:0xf bound_ctrl:0
    s_nop 1
    v_add_u32_dpp v62, v62, v62 row_bcast:15 row_mask:0xa bank_mask:0xf
    s_nop 1
    v_add_u32_dpp v62, v62, v62 row_bcast:31 row_mask:0xc bank_mask:0xf
    v_sub_u32 v62, v62, v61
    ds_bpermute_b32 v62, v57, v62
    s_mov_b64 exec, s[66:67]
    v_or_b32 v64, v59, v0
    s_waitcnt lgkmcnt(0)
    v_add_u32 v60, v60, v62
    v_mul_u32_u24 v61, 4194464, v60
    v_lshl_add_u32 v48, v48, 2, v61
    v_lshl_add_u32 v49, v49, 2, v61
    v_lshl_add_u32 v50, v50, 2, v61
    v_lshl_add_u32 v51, v51, 2, v61
    v_lshl_add_u32 v52, v52, 2, v61
    v_lshl_add_u32 v53, v53, 2, v61
    v_lshl_add_u32 v54, v54, 2, v61
    v_lshl_add_u32 v55, v55, 2, v61
    ds_write_b128 v37, v[48:51] offset:32896
    ds_write_b128 v37, v[52:55] offset:32912
    v_lshlrev_b32 v62, 4, v60
    ds_write_b128 v62, v[64:67] offset:28736
    v_lshlrev_b32 v62, 5, v60
    v_add_u32 v62, 36352, v62
    ds_write_b32 v62, v58 offset:65024
    v_cmp_lt_u32 vcc, 40, v65
    s_and_b64 exec, exec, vcc
    s_cbranch_execz p2_n3
    v_subrev_u32 v56, 40, v65
    v_mov_b32 v62, 26624
    ds_add_rtn_u32 v63, v62, v56
    v_lshlrev_b32 v62, 2, v60
    s_waitcnt lgkmcnt(0)
    ds_write_b32 v62, v63 offset:32064
    s_branch p2_n3
p2_n2:
    v_lshrrev_b32 v26, 29, v12
    v_lshrrev_b32 v27, 8, v12
    v_bfe_u32 v26, s58, v26, 1
    v_and_b32 v27, 0xffffff80, v27
    v_and_b32 v26, v26, v12
    v_lshl_add_u32 v12, v26, 13, v27
    v_lshrrev_b32 v26, 29, v13
    v_lshrrev_b32 v27, 8, v13
    v_bfe_u32 v26, s58, v26, 1
    v_and_b32 v27, 0xffffff80, v27
    v_and_b32 v26, v26, v13
    v_lshl_add_u32 v13, v26, 13, v27
    v_lshrrev_b32 v26, 29, v14
    v_lshrrev_b32 v27, 8, v14
    v_bfe_u32 v26, s58, v26, 1
    v_and_b32 v27, 0xffffff80, v27
    v_and_b32 v26, v26, v14
    v_lshl_add_u32 v14, v26, 13, v27
    v_lshrrev_b32 v26, 29, v15
    v_lshrrev_b32 v27, 8, v15
    v_bfe_u32 v26, s58, v26, 1
    v_and_b32 v27, 0xffffff80, v27
    v_and_b32 v26, v26, v15
    v_lshl_add_u32 v15, v26, 13, v27
    v_lshrrev_b32 v26, 29, v16
    v_lshrrev_b32 v27, 8, v16
    v_bfe_u32 v26, s58, v26, 1
    v_and_b32 v27, 0xffffff80, v27
    v_and_b32 v26, v26, v16
    v_lshl_add_u32 v16, v26, 13, v27
    v_lshrrev_b32 v26, 29, v17
    v_lshrrev_b32 v27, 8, v17
    v_bfe_u32 v26, s58, v26, 1
    v_and_b32 v27, 0xffffff80, v27
    v_and_b32 v26, v26, v17
    v_lshl_add_u32 v17, v26, 13, v27
    v_lshrrev_b32 v26, 29, v18
    v_lshrrev_b32 v27, 8, v18
    v_bfe_u32 v26, s58, v26, 1
    v_and_b32 v27, 0xffffff80, v27
    v_and_b32 v26, v26, v18
    v_lshl_add_u32 v18, v26, 13, v27
    v_lshrrev_b32 v26, 29, v19
    v_lshrrev_b32 v27, 8, v19
    v_bfe_u32 v26, s58, v26, 1
    v_and_b32 v27, 0xffffff80, v27
    v_and_b32 v26, v26, v19
    v_lshl_add_u32 v19, v26, 13, v27
p2_n3:
    s_mov_b64 exec, -1
    s_waitcnt lgkmcnt(0)
    s_barrier
    v_cmpx_lt_i32 vcc, 0, v20
    ds_add_rtn_u32 v40, v80, v69 offset:32896
    v_cmpx_lt_i32 vcc, 1, v20
    ds_add_rtn_u32 v41, v81, v69 offset:32896
    v_cmpx_lt_i32 vcc, 2, v20
    ds_add_rtn_u32 v42, v82, v69 offset:32896
    v_cmpx_lt_i32 vcc, 3, v20
    ds_add_rtn_u32 v43, v83, v69 offset:32896
    v_cmpx_lt_i32 vcc, 16, v20
    ds_add_rtn_u32 v44, v84, v69 offset:32896
    v_cmpx_lt_i32 vcc, 17, v20
    ds_add_rtn_u32 v45, v85, v69 offset:32896
    v_cmpx_lt_i32 vcc, 18, v20
    ds_add_rtn_u32 v46, v86, v69 offset:32896
    v_cmpx_lt_i32 vcc, 19, v20
    ds_add_rtn_u32 v47, v87, v69 offset:32896
    s_mov_b64 exec, -1
    v_mov_b32 v62, 26624
    ds_read_b32 v63, v62
    s_cmp_ge_u32 s4, 4
    s_cbranch_scc1 p2_o2
    v_lshrrev_b32 v26, 29, v12
    v_lshrrev_b32 v27, 8, v12
    v_bfe_u32 v26, s58, v26, 1
    v_and_b32 v27, 0xffffff80, v27
    v_and_b32 v26, v26, v12
    v_lshl_add_u32 v12, v26, 13, v27
    v_lshrrev_b32 v26, 29, v13
    v_lshrrev_b32 v27, 8, v13
    v_bfe_u32 v26, s58, v26, 1
    v_and_b32 v27, 0xffffff80, v27
    v_and_b32 v26, v26, v13
    v_lshl_add_u32 v13, v26, 13, v27
    v_lshrrev_b32 v26, 29, v14
    v_lshrrev_b32 v27, 8, v14
    v_bfe_u32 v26, s58, v26, 1
    v_and_b32 v27, 0xffffff80, v27
    v_and_b32 v26, v26, v14
    v_lshl_add_u32 v14, v26, 13, v27
    v_lshrrev_b32 v26, 29, v15
    v_lshrrev_b32 v27, 8, v15
    v_bfe_u32 v26, s58, v26, 1
    v_and_b32 v27, 0xffffff80, v27
    v_and_b32 v26, v26, v15
    v_lshl_add_u32 v15, v26, 13, v27
    v_lshrrev_b32 v26, 29, v16
    v_lshrrev_b32 v27, 8, v16
    v_bfe_u32 v26, s58, v26, 1
    v_and_b32 v27, 0xffffff80, v27
    v_and_b32 v26, v26, v16
    v_lshl_add_u32 v16, v26, 13, v27
    v_lshrrev_b32 v26, 29, v17
    v_lshrrev_b32 v27, 8, v17
    v_bfe_u32 v26, s58, v26, 1
    v_and_b32 v27, 0xffffff80, v27
    v_and_b32 v26, v26, v17
    v_lshl_add_u32 v17, v26, 13, v27
    v_lshrrev_b32 v26, 29, v18
    v_lshrrev_b32 v27, 8, v18
    v_bfe_u32 v26, s58, v26, 1
    v_and_b32 v27, 0xffffff80, v27
    v_and_b32 v26, v26, v18
    v_lshl_add_u32 v18, v26, 13, v27
    v_lshrrev_b32 v26, 29, v19
    v_lshrrev_b32 v27, 8, v19
    v_bfe_u32 v26, s58, v26, 1
    v_and_b32 v27, 0xffffff80, v27
    v_and_b32 v26, v26, v19
    v_lshl_add_u32 v19, v26, 13, v27
p2_o2:
    s_movk_i32 s64, 160
    s_mov_b32 s65, 0x3fffff
    s_waitcnt lgkmcnt(0)
    v_readfirstlane_b32 s59, v63
    s_cmp_lg_u32 s59, 0
    s_cbranch_scc1 p2_ovf
    v_and_b32 v40, s65, v40
    v_and_b32 v41, s65, v41
    v_and_b32 v42, s65, v42
    v_and_b32 v43, s65, v43
    v_and_b32 v44, s65, v44
    v_and_b32 v45, s65, v45
    v_and_b32 v46, s65, v46
    v_and_b32 v47, s65, v47
    v_cmpx_lt_i32 vcc, 0, v20
    ds_write_b32 v40, v12 offset:52352
    v_cmpx_lt_i32 vcc, 1, v20
    ds_write_b32 v41, v13 offset:52352
    v_cmpx_lt_i32 vcc, 2, v20
    ds_write_b32 v42, v14 offset:52352
    v_cmpx_lt_i32 vcc, 3, v20
    ds_write_b32 v43, v15 offset:52352
    v_cmpx_lt_i32 vcc, 16, v20
    ds_write_b32 v44, v16 offset:52352
    v_cmpx_lt_i32 vcc, 17, v20
    ds_write_b32 v45, v17 offset:52352
    v_cmpx_lt_i32 vcc, 18, v20
    ds_write_b32 v46, v18 offset:52352
    v_cmpx_lt_i32 vcc, 19, v20
    ds_write_b32 v47, v19 offset:52352
    s_mov_b64 exec, -1
p2_ovd:
    v_cmp_lt_i32 vcc, 32, v20
    s_cbranch_vccnz ls2
ls2_d:
    s_waitcnt vmcnt(0) lgkmcnt(0)
    s_barrier
    s_cmp_ge_u32 s4, 13
    s_cbranch_scc1 k_end
    v_mov_b32 v0, v7
    v_lshrrev_b32 v115, 3, v0
    s_lshl_b32 s64, s4, 4
    v_add_u32 v115, s64, v115
    v_and_b32 v114, 3, v0
    v_mul_u32_u24 v6, 160, v115
    v_lshl_add_u32 v7, v114, 3, v6
    v_lshl_add_u32 v6, v114, 4, v6
    ds_read_b128 v[16:19], v6 offset:52352
    ds_read_b128 v[26:29], v6 offset:53632
    v_lshlrev_b32 v116, 4, v115
    v_and_b32 v1, 7, v0
    v_lshlrev_b32 v1, 4, v1
    ds_read_b128 v[100:103], v116 offset:28736
    ds_read_b128 v[20:23], v6 offset:52416
    ds_read_b64 v[24:25], v7 offset:52480
    ds_read_b128 v[104:107], v116 offset:28864
    ds_read_b128 v[30:33], v6 offset:53696
    ds_read_b64 v[34:35], v7 offset:53760
    s_mov_b32 s32, s36
    s_mov_b32 s33, s37
    s_mov_b32 s34, s38
    s_mov_b32 s35, 0x20000
    s_mov_b32 s3, 1
    v_mov_b32 v126, -1
    s_waitcnt lgkmcnt(6)
    v_add_u32_dpp v4, v16, v1 quad_perm:[0,0,0,0] row_mask:0xf bank_mask:0xf
    v_add_u32_dpp v5, v26, v1 quad_perm:[0,0,0,0] row_mask:0xf bank_mask:0xf
    v_add_u32_dpp v6, v17, v1 quad_perm:[0,0,0,0] row_mask:0xf bank_mask:0xf
    v_add_u32_dpp v7, v27, v1 quad_perm:[0,0,0,0] row_mask:0xf bank_mask:0xf
h_top:
    s_cmp_lg_u32 s3, 7
    s_cbranch_scc1 h_nx
    s_mov_b32 exec_lo, -1
    s_mov_b32 exec_hi, 0
    s_add_u32 m0, s95, 0
    s_nop 0
    buffer_load_dwordx4 v118, s[44:47], 0 offen  lds
    s_add_u32 m0, s95, 608
    s_nop 0
    buffer_load_dwordx4 v8, s[96:99], 0 offen sc1 lds
    s_add_u32 m0, s95, 1184
    s_nop 0
    buffer_load_dwordx4 v8, s[32:35], 0 offen sc1 lds
    s_mov_b64 exec, -1
    s_setprio 3
    s_setprio 3
    s_cmp_ge_u32 s4, 8
    s_cbranch_scc1 h_nx
    s_cmp_ge_u32 s4, 4
    s_cselect_b32 s64, 4, 8
    v_mov_b32 v60, 157184
    s_mov_b32 s65, 0
h_g7:
    ds_read_b32 v61, v60
    s_waitcnt lgkmcnt(0)
    v_readfirstlane_b32 s66, v61
    s_cmp_ge_u32 s66, s64
    s_cbranch_scc1 h_nx
    s_sleep 1
    s_add_u32 s65, s65, 1
    s_cmp_lt_u32 s65, 0x1000000
    s_cbranch_scc1 h_g7
h_nx:
    buffer_load_dwordx4 v[52:55], v4, s[32:35], 0 offen sc1
    buffer_load_dwordx4 v[56:59], v5, s[32:35], 0 offen sc1
    buffer_load_dwordx4 v[60:63], v6, s[32:35], 0 offen sc1
    buffer_load_dwordx4 v[64:67], v7, s[32:35], 0 offen sc1
    s_cmp_eq_u32 s3, 1
    s_cbranch_scc1 h_def
h_defr:
    v_mov_b32 v36, 0
    v_mov_b32 v37, 0
    v_mov_b32 v38, 0
    v_mov_b32 v39, 0
    v_mov_b32 v40, 0
    v_mov_b32 v41, 0
    v_mov_b32 v42, 0
    v_mov_b32 v43, 0
    v_mov_b32 v44, 0
    v_mov_b32 v45, 0
    v_mov_b32 v46, 0
    v_mov_b32 v47, 0
    v_mov_b32 v48, 0
    v_mov_b32 v49, 0
    v_mov_b32 v50, 0
    v_mov_b32 v51, 0
    s_mov_b32 s77, s52
    s_mov_b32 s78, 0
    s_cmp_eq_u32 s3, 7
    s_cselect_b32 s78, 8, 0
    s_sub_u32 s77, s77, 24
    s_cbranch_scc1 h_ev1
h_ev1_r:
    v_add_u32_dpp v4, v18, v1 quad_perm:[0,0,0,0] row_mask:0xf bank_mask:0xf
    v_add_u32_dpp v5, v28, v1 quad_perm:[0,0,0,0] row_mask:0xf bank_mask:0xf
    v_add_u32_dpp v6, v19, v1 quad_perm:[0,0,0,0] row_mask:0xf bank_mask:0xf
    v_add_u32_dpp v7, v29, v1 quad_perm:[0,0,0,0] row_mask:0xf bank_mask:0xf
    buffer_load_dwordx4 v[68:71], v4, s[32:35], 0 offen sc1
    buffer_load_dwordx4 v[72:75], v5, s[32:35], 0 offen sc1
    buffer_load_dwordx4 v[76:79], v6, s[32:35], 0 offen sc1
    buffer_load_dwordx4 v[80:83], v7, s[32:35], 0 offen sc1
    s_cmp_ge_u32 4, s52
    s_cbranch_scc1 h_drain0
    s_sub_u32 s77, s77, 24
    s_cbranch_scc1 h_ev2
h_ev2_r:
    v_add_u32_dpp v4, v16, v1 quad_perm:[1,1,1,1] row_mask:0xf bank_mask:0xf
    v_add_u32_dpp v5, v26, v1 quad_perm:[1,1,1,1] row_mask:0xf bank_mask:0xf
    v_add_u32_dpp v6, v17, v1 quad_perm:[1,1,1,1] row_mask:0xf bank_mask:0xf
    v_add_u32_dpp v7, v27, v1 quad_perm:[1,1,1,1] row_mask:0xf bank_mask:0xf
    s_waitcnt vmcnt(4)
    v_mfma_f32_4x4x4_16b_bf16 v[36:39], v[2:3], v[52:53], v[36:39]
    v_mfma_f32_4x4x4_16b_bf16 v[40:43], v[2:3], v[54:55], v[40:43]
    v_mfma_f32_4x4x4_16b_bf16 v[44:47], v[2:3], v[56:57], v[44:47]
    v_mfma_f32_4x4x4_16b_bf16 v[48:51], v[2:3], v[58:59], v[48:51]
    v_mfma_f32_4x4x4_16b_bf16 v[36:39], v[2:3], v[60:61], v[36:39]
    v_mfma_f32_4x4x4_16b_bf16 v[40:43], v[2:3], v[62:63], v[40:43]
    v_mfma_f32_4x4x4_16b_bf16 v[44:47], v[2:3], v[64:65], v[44:47]
    v_mfma_f32_4x4x4_16b_bf16 v[48:51], v[2:3], v[66:67], v[48:51]
    buffer_load_dwordx4 v[52:55], v4, s[32:35], 0 offen sc1
    buffer_load_dwordx4 v[56:59], v5, s[32:35], 0 offen sc1
    buffer_load_dwordx4 v[60:63], v6, s[32:35], 0 offen sc1
    buffer_load_dwordx4 v[64:67], v7, s[32:35], 0 offen sc1
    s_cmp_ge_u32 6, s52
    s_cbranch_scc1 h_drain1
    s_sub_u32 s77, s77, 24
    s_cbranch_scc1 h_ev3
h_ev3_r:
    v_add_u32_dpp v4, v18, v1 quad_perm:[1,1,1,1] row_mask:0xf bank_mask:0xf
    v_add_u32_dpp v5, v28, v1 quad_perm:[1,1,1,1] row_mask:0xf bank_mask:0xf
    v_add_u32_dpp v6, v19, v1 quad_perm:[1,1,1,1] row_mask:0xf bank_mask:0xf
    v_add_u32_dpp v7, v29, v1 quad_perm:[1,1,1,1] row_mask:0xf bank_mask:0xf
    s_waitcnt vmcnt(4)
    v_mfma_f32_4x4x4_16b_bf16 v[36:39], v[2:3], v[68:69], v[36:39]
    v_mfma_f32_4x4x4_16b_bf16 v[40:43], v[2:3], v[70:71], v[40:43]
    v_mfma_f32_4x4x4_16b_bf16 v[44:47], v[2:3], v[72:73], v[44:47]
    v_mfma_f32_4x4x4_16b_bf16 v[48:51], v[2:3], v[74:75], v[48:51]
    v_mfma_f32_4x4x4_16b_bf16 v[36:39], v[2:3], v[76:77], v[36:39]
    v_mfma_f32_4x4x4_16b_bf16 v[40:43], v[2:3], v[78:79], v[40:43]
    v_mfma_f32_4x4x4_16b_bf16 v[44:47], v[2:3], v[80:81], v[44:47]
    v_mfma_f32_4x4x4_16b_bf16 v[48:51], v[2:3], v[82:83], v[48:51]
    buffer_load_dwordx4 v[68:71], v4, s[32:35], 0 offen sc1
    buffer_load_dwordx4 v[72:75], v5, s[32:35], 0 offen sc1
    buffer_load_dwordx4 v[76:79], v6, s[32:35], 0 offen sc1
    buffer_load_dwordx4 v[80:83], v7, s[32:35], 0 offen sc1
    s_cmp_ge_u32 8, s52
    s_cbranch_scc1 h_drain0
    s_sub_u32 s77, s77, 24
    s_cbranch_scc1 h_ev4
h_ev4_r:
    v_add_u32_dpp v4, v16, v1 quad_perm:[2,2,2,2] row_mask:0xf bank_mask:0xf
    v_add_u32_dpp v5, v26, v1 quad_perm:[2,2,2,2] row_mask:0xf bank_mask:0xf
    v_add_u32_dpp v6, v17, v1 quad_perm:[2,2,2,2] row_mask:0xf bank_mask:0xf
    v_add_u32_dpp v7, v27, v1 quad_perm:[2,2,2,2] row_mask:0xf bank_mask:0xf
    s_waitcnt vmcnt(4)
    v_mfma_f32_4x4x4_16b_bf16 v[36:39], v[2:3], v[52:53], v[36:39]
    v_mfma_f32_4x4x4_16b_bf16 v[40:43], v[2:3], v[54:55], v[40:43]
    v_mfma_f32_4x4x4_16b_bf16 v[44:47], v[2:3], v[56:57], v[44:47]
    v_mfma_f32_4x4x4_16b_bf16 v[48:51], v[2:3], v[58:59], v[48:51]
    v_mfma_f32_4x4x4_16b_bf16 v[36:39], v[2:3], v[60:61], v[36:39]
    v_mfma_f32_4x4x4_16b_bf16 v[40:43], v[2:3], v[62:63], v[40:43]
    v_mfma_f32_4x4x4_16b_bf16 v[44:47], v[2:3], v[64:65], v[44:47]
    v_mfma_f32_4x4x4_16b_bf16 v[48:51], v[2:3], v[66:67], v[48:51]
    buffer_load_dwordx4 v[52:55], v4, s[32:35], 0 offen sc1
    buffer_load_dwordx4 v[56:59], v5, s[32:35], 0 offen sc1
    buffer_load_dwordx4 v[60:63], v6, s[32:35], 0 offen sc1
    buffer_load_dwordx4 v[64:67], v7, s[32:35], 0 offen sc1
    s_cmp_ge_u32 10, s52
    s_cbranch_scc1 h_drain1
    s_sub_u32 s77, s77, 24
    s_cbranch_scc1 h_ev5
h_ev5_r:
    v_add_u32_dpp v4, v18, v1 quad_perm:[2,2,2,2] row_mask:0xf bank_mask:0xf
    v_add_u32_dpp v5, v28, v1 quad_perm:[2,2,2,2] row_mask:0xf bank_mask:0xf
    v_add_u32_dpp v6, v19, v1 quad_perm:[2,2,2,2] row_mask:0xf bank_mask:0xf
    v_add_u32_dpp v7, v29, v1 quad_perm:[2,2,2,2] row_mask:0xf bank_mask:0xf
    s_waitcnt vmcnt(4)
    v_mfma_f32_4x4x4_16b_bf16 v[36:39], v[2:3], v[68:69], v[36:39]
    v_mfma_f32_4x4x4_16b_bf16 v[40:43], v[2:3], v[70:71], v[40:43]
    v_mfma_f32_4x4x4_16b_bf16 v[44:47], v[2:3], v[72:73], v[44:47]
    v_mfma_f32_4x4x4_16b_bf16 v[48:51], v[2:3], v[74:75], v[48:51]
    v_mfma_f32_4x4x4_16b_bf16 v[36:39], v[2:3], v[76:77], v[36:39]
    v_mfma_f32_4x4x4_16b_bf16 v[40:43], v[2:3], v[78:79], v[40:43]
    v_mfma_f32_4x4x4_16b_bf16 v[44:47], v[2:3], v[80:81], v[44:47]
    v_mfma_f32_4x4x4_16b_bf16 v[48:51], v[2:3], v[82:83], v[48:51]
    buffer_load_dwordx4 v[68:71], v4, s[32:35], 0 offen sc1
    buffer_load_dwordx4 v[72:75], v5, s[32:35], 0 offen sc1
    buffer_load_dwordx4 v[76:79], v6, s[32:35], 0 offen sc1
    buffer_load_dwordx4 v[80:83], v7, s[32:35], 0 offen sc1
    s_cmp_ge_u32 12, s52
    s_cbranch_scc1 h_drain0
    s_sub_u32 s77, s77, 24
    s_cbranch_scc1 h_ev6
h_ev6_r:
    v_add_u32_dpp v4, v16, v1 quad_perm:[3,3,3,3] row_mask:0xf bank_mask:0xf
    v_add_u32_dpp v5, v26, v1 quad_perm:[3,3,3,3] row_mask:0xf bank_mask:0xf
    v_add_u32_dpp v6, v17, v1 quad_perm:[3,3,3,3] row_mask:0xf bank_mask:0xf
    v_add_u32_dpp v7, v27, v1 quad_perm:[3,3,3,3] row_mask:0xf bank_mask:0xf
    s_waitcnt vmcnt(4)
    v_mfma_f32_4x4x4_16b_bf16 v[36:39], v[2:3], v[52:53], v[36:39]
    v_mfma_f32_4x4x4_16b_bf16 v[40:43], v[2:3], v[54:55], v[40:43]
    v_mfma_f32_4x4x4_16b_bf16 v[44:47], v[2:3], v[56:57], v[44:47]
    v_mfma_f32_4x4x4_16b_bf16 v[48:51], v[2:3], v[58:59], v[48:51]
    v_mfma_f32_4x4x4_16b_bf16 v[36:39], v[2:3], v[60:61], v[36:39]
    v_mfma_f32_4x4x4_16b_bf16 v[40:43], v[2:3], v[62:63], v[40:43]
    v_mfma_f32_4x4x4_16b_bf16 v[44:47], v[2:3], v[64:65], v[44:47]
    v_mfma_f32_4x4x4_16b_bf16 v[48:51], v[2:3], v[66:67], v[48:51]
    buffer_load_dwordx4 v[52:55], v4, s[32:35], 0 offen sc1
    buffer_load_dwordx4 v[56:59], v5, s[32:35], 0 offen sc1
    buffer_load_dwordx4 v[60:63], v6, s[32:35], 0 offen sc1
    buffer_load_dwordx4 v[64:67], v7, s[32:35], 0 offen sc1
    s_cmp_ge_u32 14, s52
    s_cbranch_scc1 h_drain1
    s_sub_u32 s77, s77, 24
    s_cbranch_scc1 h_ev7
h_ev7_r:
    v_add_u32_dpp v4, v18, v1 quad_perm:[3,3,3,3] row_mask:0xf bank_mask:0xf
    v_add_u32_dpp v5, v28, v1 quad_perm:[3,3,3,3] row_mask:0xf bank_mask:0xf
    v_add_u32_dpp v6, v19, v1 quad_perm:[3,3,3,3] row_mask:0xf bank_mask:0xf
    v_add_u32_dpp v7, v29, v1 quad_perm:[3,3,3,3] row_mask:0xf bank_mask:0xf
    s_waitcnt vmcnt(4)
    v_mfma_f32_4x4x4_16b_bf16 v[36:39], v[2:3], v[68:69], v[36:39]
    v_mfma_f32_4x4x4_16b_bf16 v[40:43], v[2:3], v[70:71], v[40:43]
    v_mfma_f32_4x4x4_16b_bf16 v[44:47], v[2:3], v[72:73], v[44:47]
    v_mfma_f32_4x4x4_16b_bf16 v[48:51], v[2:3], v[74:75], v[48:51]
    v_mfma_f32_4x4x4_16b_bf16 v[36:39], v[2:3], v[76:77], v[36:39]
    v_mfma_f32_4x4x4_16b_bf16 v[40:43], v[2:3], v[78:79], v[40:43]
    v_mfma_f32_4x4x4_16b_bf16 v[44:47], v[2:3], v[80:81], v[44:47]
    v_mfma_f32_4x4x4_16b_bf16 v[48:51], v[2:3], v[82:83], v[48:51]
    buffer_load_dwordx4 v[68:71], v4, s[32:35], 0 offen sc1
    buffer_load_dwordx4 v[72:75], v5, s[32:35], 0 offen sc1
    buffer_load_dwordx4 v[76:79], v6, s[32:35], 0 offen sc1
    buffer_load_dwordx4 v[80:83], v7, s[32:35], 0 offen sc1
    s_cmp_ge_u32 16, s52
    s_cbranch_scc1 h_drain0
    s_sub_u32 s77, s77, 24
    s_cbranch_scc1 h_ev8
h_ev8_r:
    v_add_u32_dpp v4, v20, v1 quad_perm:[0,0,0,0] row_mask:0xf bank_mask:0xf
    v_add_u32_dpp v5, v30, v1 quad_perm:[0,0,0,0] row_mask:0xf bank_mask:0xf
    v_add_u32_dpp v6, v21, v1 quad_perm:[0,0,0,0] row_mask:0xf bank_mask:0xf
    v_add_u32_dpp v7, v31, v1 quad_perm:[0,0,0,0] row_mask:0xf bank_mask:0xf
    s_waitcnt vmcnt(4)
    v_mfma_f32_4x4x4_16b_bf16 v[36:39], v[2:3], v[52:53], v[36:39]
    v_mfma_f32_4x4x4_16b_bf16 v[40:43], v[2:3], v[54:55], v[40:43]
    v_mfma_f32_4x4x4_16b_bf16 v[44:47], v[2:3], v[56:57], v[44:47]
    v_mfma_f32_4x4x4_16b_bf16 v[48:51], v[2:3], v[58:59], v[48:51]
    v_mfma_f32_4x4x4_16b_bf16 v[36:39], v[2:3], v[60:61], v[36:39]
    v_mfma_f32_4x4x4_16b_bf16 v[40:43], v[2:3], v[62:63], v[40:43]
    v_mfma_f32_4x4x4_16b_bf16 v[44:47], v[2:3], v[64:65], v[44:47]
    v_mfma_f32_4x4x4_16b_bf16 v[48:51], v[2:3], v[66:67], v[48:51]
    buffer_load_dwordx4 v[52:55], v4, s[32:35], 0 offen sc1
    buffer_load_dwordx4 v[56:59], v5, s[32:35], 0 offen sc1
    buffer_load_dwordx4 v[60:63], v6, s[32:35], 0 offen sc1
    buffer_load_dwordx4 v[64:67], v7, s[32:35], 0 offen sc1
    s_cmp_ge_u32 18, s52
    s_cbranch_scc1 h_drain1
    s_sub_u32 s77, s77, 24
    s_cbranch_scc1 h_ev9
h_ev9_r:
    v_add_u32_dpp v4, v22, v1 quad_perm:[0,0,0,0] row_mask:0xf bank_mask:0xf
    v_add_u32_dpp v5, v32, v1 quad_perm:[0,0,0,0] row_mask:0xf bank_mask:0xf
    v_add_u32_dpp v6, v23, v1 quad_perm:[0,0,0,0] row_mask:0xf bank_mask:0xf
    v_add_u32_dpp v7, v33, v1 quad_perm:[0,0,0,0] row_mask:0xf bank_mask:0xf
    s_waitcnt vmcnt(4)
    v_mfma_f32_4x4x4_16b_bf16 v[36:39], v[2:3], v[68:69], v[36:39]
    v_mfma_f32_4x4x4_16b_bf16 v[40:43], v[2:3], v[70:71], v[40:43]
    v_mfma_f32_4x4x4_16b_bf16 v[44:47], v[2:3], v[72:73], v[44:47]
    v_mfma_f32_4x4x4_16b_bf16 v[48:51], v[2:3], v[74:75], v[48:51]
    v_mfma_f32_4x4x4_16b_bf16 v[36:39], v[2:3], v[76:77], v[36:39]
    v_mfma_f32_4x4x4_16b_bf16 v[40:43], v[2:3], v[78:79], v[40:43]
    v_mfma_f32_4x4x4_16b_bf16 v[44:47], v[2:3], v[80:81], v[44:47]
    v_mfma_f32_4x4x4_16b_bf16 v[48:51], v[2:3], v[82:83], v[48:51]
    buffer_load_dwordx4 v[68:71], v4, s[32:35], 0 offen sc1
    buffer_load_dwordx4 v[72:75], v5, s[32:35], 0 offen sc1
    buffer_load_dwordx4 v[76:79], v6, s[32:35], 0 offen sc1
    buffer_load_dwordx4 v[80:83], v7, s[32:35], 0 offen sc1
    s_cmp_ge_u32 20, s52
    s_cbranch_scc1 h_drain0
    s_sub_u32 s77, s77, 24
    s_cbranch_scc1 h_ev10
h_ev10_r:
    v_add_u32_dpp v4, v20, v1 quad_perm:[1,1,1,1] row_mask:0xf bank_mask:0xf
    v_add_u32_dpp v5, v30, v1 quad_perm:[1,1,1,1] row_mask:0xf bank_mask:0xf
    v_add_u32_dpp v6, v21, v1 quad_perm:[1,1,1,1] row_mask:0xf bank_mask:0xf
    v_add_u32_dpp v7, v31, v1 quad_perm:[1,1,1,1] row_mask:0xf bank_mask:0xf
    s_waitcnt vmcnt(4)
    v_mfma_f32_4x4x4_16b_bf16 v[36:39], v[2:3], v[52:53], v[36:39]
    v_mfma_f32_4x4x4_16b_bf16 v[40:43], v[2:3], v[54:55], v[40:43]
    v_mfma_f32_4x4x4_16b_bf16 v[44:47], v[2:3], v[56:57], v[44:47]
    v_mfma_f32_4x4x4_16b_bf16 v[48:51], v[2:3], v[58:59], v[48:51]
    v_mfma_f32_4x4x4_16b_bf16 v[36:39], v[2:3], v[60:61], v[36:39]
    v_mfma_f32_4x4x4_16b_bf16 v[40:43], v[2:3], v[62:63], v[40:43]
    v_mfma_f32_4x4x4_16b_bf16 v[44:47], v[2:3], v[64:65], v[44:47]
    v_mfma_f32_4x4x4_16b_bf16 v[48:51], v[2:3], v[66:67], v[48:51]
    buffer_load_dwordx4 v[52:55], v4, s[32:35], 0 offen sc1
    buffer_load_dwordx4 v[56:59], v5, s[32:35], 0 offen sc1
    buffer_load_dwordx4 v[60:63], v6, s[32:35], 0 offen sc1
    buffer_load_dwordx4 v[64:67], v7, s[32:35], 0 offen sc1
    s_cmp_ge_u32 22, s52
    s_cbranch_scc1 h_drain1
    s_sub_u32 s77, s77, 24
    s_cbranch_scc1 h_ev11
h_ev11_r:
    v_add_u32_dpp v4, v22, v1 quad_perm:[1,1,1,1] row_mask:0xf bank_mask:0xf
    v_add_u32_dpp v5, v32, v1 quad_perm:[1,1,1,1] row_mask:0xf bank_mask:0xf
    v_add_u32_dpp v6, v23, v1 quad_perm:[1,1,1,1] row_mask:0xf bank_mask:0xf
    v_add_u32_dpp v7, v33, v1 quad_perm:[1,1,1,1] row_mask:0xf bank_mask:0xf
    s_waitcnt vmcnt(4)
    v_mfma_f32_4x4x4_16b_bf16 v[36:39], v[2:3], v[68:69], v[36:39]
    v_mfma_f32_4x4x4_16b_bf16 v[40:43], v[2:3], v[70:71], v[40:43]
    v_mfma_f32_4x4x4_16b_bf16 v[44:47], v[2:3], v[72:73], v[44:47]
    v_mfma_f32_4x4x4_16b_bf16 v[48:51], v[2:3], v[74:75], v[48:51]
    v_mfma_f32_4x4x4_16b_bf16 v[36:39], v[2:3], v[76:77], v[36:39]
    v_mfma_f32_4x4x4_16b_bf16 v[40:43], v[2:3], v[78:79], v[40:43]
    v_mfma_f32_4x4x4_16b_bf16 v[44:47], v[2:3], v[80:81], v[44:47]
    v_mfma_f32_4x4x4_16b_bf16 v[48:51], v[2:3], v[82:83], v[48:51]
    buffer_load_dwordx4 v[68:71], v4, s[32:35], 0 offen sc1
    buffer_load_dwordx4 v[72:75], v5, s[32:35], 0 offen sc1
    buffer_load_dwordx4 v[76:79], v6, s[32:35], 0 offen sc1
    buffer_load_dwordx4 v[80:83], v7, s[32:35], 0 offen sc1
    s_cmp_ge_u32 24, s52
    s_cbranch_scc1 h_drain0
    s_sub_u32 s77, s77, 24
    s_cbranch_scc1 h_ev12
h_ev12_r:
    v_add_u32_dpp v4, v20, v1 quad_perm:[2,2,2,2] row_mask:0xf bank_mask:0xf
    v_add_u32_dpp v5, v30, v1 quad_perm:[2,2,2,2] row_mask:0xf bank_mask:0xf
    v_add_u32_dpp v6, v21, v1 quad_perm:[2,2,2,2] row_mask:0xf bank_mask:0xf
    v_add_u32_dpp v7, v31, v1 quad_perm:[2,2,2,2] row_mask:0xf bank_mask:0xf
    s_waitcnt vmcnt(4)
    v_mfma_f32_4x4x4_16b_bf16 v[36:39], v[2:3], v[52:53], v[36:39]
    v_mfma_f32_4x4x4_16b_bf16 v[40:43], v[2:3], v[54:55], v[40:43]
    v_mfma_f32_4x4x4_16b_bf16 v[44:47], v[2:3], v[56:57], v[44:47]
    v_mfma_f32_4x4x4_16b_bf16 v[48:51], v[2:3], v[58:59], v[48:51]
    v_mfma_f32_4x4x4_16b_bf16 v[36:39], v[2:3], v[60:61], v[36:39]
    v_mfma_f32_4x4x4_16b_bf16 v[40:43], v[2:3], v[62:63], v[40:43]
    v_mfma_f32_4x4x4_16b_bf16 v[44:47], v[2:3], v[64:65], v[44:47]
    v_mfma_f32_4x4x4_16b_bf16 v[48:51], v[2:3], v[66:67], v[48:51]
    buffer_load_dwordx4 v[52:55], v4, s[32:35], 0 offen sc1
    buffer_load_dwordx4 v[56:59], v5, s[32:35], 0 offen sc1
    buffer_load_dwordx4 v[60:63], v6, s[32:35], 0 offen sc1
    buffer_load_dwordx4 v[64:67], v7, s[32:35], 0 offen sc1
    s_cmp_ge_u32 26, s52
    s_cbranch_scc1 h_drain1
    s_sub_u32 s77, s77, 24
    s_cbranch_scc1 h_ev13
h_ev13_r:
    v_add_u32_dpp v4, v22, v1 quad_perm:[2,2,2,2] row_mask:0xf bank_mask:0xf
    v_add_u32_dpp v5, v32, v1 quad_perm:[2,2,2,2] row_mask:0xf bank_mask:0xf
    v_add_u32_dpp v6, v23, v1 quad_perm:[2,2,2,2] row_mask:0xf bank_mask:0xf
    v_add_u32_dpp v7, v33, v1 quad_perm:[2,2,2,2] row_mask:0xf bank_mask:0xf
    s_waitcnt vmcnt(4)
    v_mfma_f32_4x4x4_16b_bf16 v[36:39], v[2:3], v[68:69], v[36:39]
    v_mfma_f32_4x4x4_16b_bf16 v[40:43], v[2:3], v[70:71], v[40:43]
    v_mfma_f32_4x4x4_16b_bf16 v[44:47], v[2:3], v[72:73], v[44:47]
    v_mfma_f32_4x4x4_16b_bf16 v[48:51], v[2:3], v[74:75], v[48:51]
    v_mfma_f32_4x4x4_16b_bf16 v[36:39], v[2:3], v[76:77], v[36:39]
    v_mfma_f32_4x4x4_16b_bf16 v[40:43], v[2:3], v[78:79], v[40:43]
    v_mfma_f32_4x4x4_16b_bf16 v[44:47], v[2:3], v[80:81], v[44:47]
    v_mfma_f32_4x4x4_16b_bf16 v[48:51], v[2:3], v[82:83], v[48:51]
    buffer_load_dwordx4 v[68:71], v4, s[32:35], 0 offen sc1
    buffer_load_dwordx4 v[72:75], v5, s[32:35], 0 offen sc1
    buffer_load_dwordx4 v[76:79], v6, s[32:35], 0 offen sc1
    buffer_load_dwordx4 v[80:83], v7, s[32:35], 0 offen sc1
    s_cmp_ge_u32 28, s52
    s_cbranch_scc1 h_drain0
    s_sub_u32 s77, s77, 24
    s_cbranch_scc1 h_ev14
h_ev14_r:
    v_add_u32_dpp v4, v20, v1 quad_perm:[3,3,3,3] row_mask:0xf bank_mask:0xf
    v_add_u32_dpp v5, v30, v1 quad_perm:[3,3,3,3] row_mask:0xf bank_mask:0xf
    v_add_u32_dpp v6, v21, v1 quad_perm:[3,3,3,3] row_mask:0xf bank_mask:0xf
    v_add_u32_dpp v7, v31, v1 quad_perm:[3,3,3,3] row_mask:0xf bank_mask:0xf
    s_waitcnt vmcnt(4)
    v_mfma_f32_4x4x4_16b_bf16 v[36:39], v[2:3], v[52:53], v[36:39]
    v_mfma_f32_4x4x4_16b_bf16 v[40:43], v[2:3], v[54:55], v[40:43]
    v_mfma_f32_4x4x4_16b_bf16 v[44:47], v[2:3], v[56:57], v[44:47]
    v_mfma_f32_4x4x4_16b_bf16 v[48:51], v[2:3], v[58:59], v[48:51]
    v_mfma_f32_4x4x4_16b_bf16 v[36:39], v[2:3], v[60:61], v[36:39]
    v_mfma_f32_4x4x4_16b_bf16 v[40:43], v[2:3], v[62:63], v[40:43]
    v_mfma_f32_4x4x4_16b_bf16 v[44:47], v[2:3], v[64:65], v[44:47]
    v_mfma_f32_4x4x4_16b_bf16 v[48:51], v[2:3], v[66:67], v[48:51]
    buffer_load_dwordx4 v[52:55], v4, s[32:35], 0 offen sc1
    buffer_load_dwordx4 v[56:59], v5, s[32:35], 0 offen sc1
    buffer_load_dwordx4 v[60:63], v6, s[32:35], 0 offen sc1
    buffer_load_dwordx4 v[64:67], v7, s[32:35], 0 offen sc1
    s_cmp_ge_u32 30, s52
    s_cbranch_scc1 h_drain1
    s_sub_u32 s77, s77, 24
    s_cbranch_scc1 h_ev15
h_ev15_r:
    v_add_u32_dpp v4, v22, v1 quad_perm:[3,3,3,3] row_mask:0xf bank_mask:0xf
    v_add_u32_dpp v5, v32, v1 quad_perm:[3,3,3,3] row_mask:0xf bank_mask:0xf
    v_add_u32_dpp v6, v23, v1 quad_perm:[3,3,3,3] row_mask:0xf bank_mask:0xf
    v_add_u32_dpp v7, v33, v1 quad_perm:[3,3,3,3] row_mask:0xf bank_mask:0xf
    s_waitcnt vmcnt(4)
    v_mfma_f32_4x4x4_16b_bf16 v[36:39], v[2:3], v[68:69], v[36:39]
    v_mfma_f32_4x4x4_16b_bf16 v[40:43], v[2:3], v[70:71], v[40:43]
    v_mfma_f32_4x4x4_16b_bf16 v[44:47], v[2:3], v[72:73], v[44:47]
    v_mfma_f32_4x4x4_16b_bf16 v[48:51], v[2:3], v[74:75], v[48:51]
    v_mfma_f32_4x4x4_16b_bf16 v[36:39], v[2:3], v[76:77], v[36:39]
    v_mfma_f32_4x4x4_16b_bf16 v[40:43], v[2:3], v[78:79], v[40:43]
    v_mfma_f32_4x4x4_16b_bf16 v[44:47], v[2:3], v[80:81], v[44:47]
    v_mfma_f32_4x4x4_16b_bf16 v[48:51], v[2:3], v[82:83], v[48:51]
    buffer_load_dwordx4 v[68:71], v4, s[32:35], 0 offen sc1
    buffer_load_dwordx4 v[72:75], v5, s[32:35], 0 offen sc1
    buffer_load_dwordx4 v[76:79], v6, s[32:35], 0 offen sc1
    buffer_load_dwordx4 v[80:83], v7, s[32:35], 0 offen sc1
    s_cmp_ge_u32 32, s52
    s_cbranch_scc1 h_drain0
    s_sub_u32 s77, s77, 24
    s_cbranch_scc1 h_ev16
h_ev16_r:
    v_add_u32_dpp v4, v24, v1 quad_perm:[0,0,0,0] row_mask:0xf bank_mask:0xf
    v_add_u32_dpp v5, v34, v1 quad_perm:[0,0,0,0] row_mask:0xf bank_mask:0xf
    v_add_u32_dpp v6, v25, v1 quad_perm:[0,0,0,0] row_mask:0xf bank_mask:0xf
    v_add_u32_dpp v7, v35, v1 quad_perm:[0,0,0,0] row_mask:0xf bank_mask:0xf
    s_waitcnt vmcnt(4)
    v_mfma_f32_4x4x4_16b_bf16 v[36:39], v[2:3], v[52:53], v[36:39]
    v_mfma_f32_4x4x4_16b_bf16 v[40:43], v[2:3], v[54:55], v[40:43]
    v_mfma_f32_4x4x4_16b_bf16 v[44:47], v[2:3], v[56:57], v[44:47]
    v_mfma_f32_4x4x4_16b_bf16 v[48:51], v[2:3], v[58:59], v[48:51]
    v_mfma_f32_4x4x4_16b_bf16 v[36:39], v[2:3], v[60:61], v[36:39]
    v_mfma_f32_4x4x4_16b_bf16 v[40:43], v[2:3], v[62:63], v[40:43]
    v_mfma_f32_4x4x4_16b_bf16 v[44:47], v[2:3], v[64:65], v[44:47]
    v_mfma_f32_4x4x4_16b_bf16 v[48:51], v[2:3], v[66:67], v[48:51]
    buffer_load_dwordx4 v[52:55], v4, s[32:35], 0 offen sc1
    buffer_load_dwordx4 v[56:59], v5, s[32:35], 0 offen sc1
    buffer_load_dwordx4 v[60:63], v6, s[32:35], 0 offen sc1
    buffer_load_dwordx4 v[64:67], v7, s[32:35], 0 offen sc1
    s_cmp_ge_u32 34, s52
    s_cbranch_scc1 h_drain1
    s_sub_u32 s77, s77, 24
    s_cbranch_scc1 h_ev17
h_ev17_r:
    v_add_u32_dpp v4, v24, v1 quad_perm:[1,1,1,1] row_mask:0xf bank_mask:0xf
    v_add_u32_dpp v5, v34, v1 quad_perm:[1,1,1,1] row_mask:0xf bank_mask:0xf
    v_add_u32_dpp v6, v25, v1 quad_perm:[1,1,1,1] row_mask:0xf bank_mask:0xf
    v_add_u32_dpp v7, v35, v1 quad_perm:[1,1,1,1] row_mask:0xf bank_mask:0xf
    s_waitcnt vmcnt(4)
    v_mfma_f32_4x4x4_16b_bf16 v[36:39], v[2:3], v[68:69], v[36:39]
    v_mfma_f32_4x4x4_16b_bf16 v[40:43], v[2:3], v[70:71], v[40:43]
    v_mfma_f32_4x4x4_16b_bf16 v[44:47], v[2:3], v[72:73], v[44:47]
    v_mfma_f32_4x4x4_16b_bf16 v[48:51], v[2:3], v[74:75], v[48:51]
    v_mfma_f32_4x4x4_16b_bf16 v[36:39], v[2:3], v[76:77], v[36:39]
    v_mfma_f32_4x4x4_16b_bf16 v[40:43], v[2:3], v[78:79], v[40:43]
    v_mfma_f32_4x4x4_16b_bf16 v[44:47], v[2:3], v[80:81], v[44:47]
    v_mfma_f32_4x4x4_16b_bf16 v[48:51], v[2:3], v[82:83], v[48:51]
    buffer_load_dwordx4 v[68:71], v4, s[32:35], 0 offen sc1
    buffer_load_dwordx4 v[72:75], v5, s[32:35], 0 offen sc1
    buffer_load_dwordx4 v[76:79], v6, s[32:35], 0 offen sc1
    buffer_load_dwordx4 v[80:83], v7, s[32:35], 0 offen sc1
    s_cmp_ge_u32 36, s52
    s_cbranch_scc1 h_drain0
    s_sub_u32 s77, s77, 24
    s_cbranch_scc1 h_ev18
h_ev18_r:
    v_add_u32_dpp v4, v24, v1 quad_perm:[2,2,2,2] row_mask:0xf bank_mask:0xf
    v_add_u32_dpp v5, v34, v1 quad_perm:[2,2,2,2] row_mask:0xf bank_mask:0xf
    v_add_u32_dpp v6, v25, v1 quad_perm:[2,2,2,2] row_mask:0xf bank_mask:0xf
    v_add_u32_dpp v7, v35, v1 quad_perm:[2,2,2,2] row_mask:0xf bank_mask:0xf
    s_waitcnt vmcnt(4)
    v_mfma_f32_4x4x4_16b_bf16 v[36:39], v[2:3], v[52:53], v[36:39]
    v_mfma_f32_4x4x4_16b_bf16 v[40:43], v[2:3], v[54:55], v[40:43]
    v_mfma_f32_4x4x4_16b_bf16 v[44:47], v[2:3], v[56:57], v[44:47]
    v_mfma_f32_4x4x4_16b_bf16 v[48:51], v[2:3], v[58:59], v[48:51]
    v_mfma_f32_4x4x4_16b_bf16 v[36:39], v[2:3], v[60:61], v[36:39]
    v_mfma_f32_4x4x4_16b_bf16 v[40:43], v[2:3], v[62:63], v[40:43]
    v_mfma_f32_4x4x4_16b_bf16 v[44:47], v[2:3], v[64:65], v[44:47]
    v_mfma_f32_4x4x4_16b_bf16 v[48:51], v[2:3], v[66:67], v[48:51]
    buffer_load_dwordx4 v[52:55], v4, s[32:35], 0 offen sc1
    buffer_load_dwordx4 v[56:59], v5, s[32:35], 0 offen sc1
    buffer_load_dwordx4 v[60:63], v6, s[32:35], 0 offen sc1
    buffer_load_dwordx4 v[64:67], v7, s[32:35], 0 offen sc1
    s_cmp_ge_u32 38, s52
    s_cbranch_scc1 h_drain1
    s_sub_u32 s77, s77, 24
    s_cbranch_scc1 h_ev19
h_ev19_r:
    v_add_u32_dpp v4, v24, v1 quad_perm:[3,3,3,3] row_mask:0xf bank_mask:0xf
    v_add_u32_dpp v5, v34, v1 quad_perm:[3,3,3,3] row_mask:0xf bank_mask:0xf
    v_add_u32_dpp v6, v25, v1 quad_perm:[3,3,3,3] row_mask:0xf bank_mask:0xf
    v_add_u32_dpp v7, v35, v1 quad_perm:[3,3,3,3] row_mask:0xf bank_mask:0xf
    s_waitcnt vmcnt(4)
    v_mfma_f32_4x4x4_16b_bf16 v[36:39], v[2:3], v[68:69], v[36:39]
    v_mfma_f32_4x4x4_16b_bf16 v[40:43], v[2:3], v[70:71], v[40:43]
    v_mfma_f32_4x4x4_16b_bf16 v[44:47], v[2:3], v[72:73], v[44:47]
    v_mfma_f32_4x4x4_16b_bf16 v[48:51], v[2:3], v[74:75], v[48:51]
    v_mfma_f32_4x4x4_16b_bf16 v[36:39], v[2:3], v[76:77], v[36:39]
    v_mfma_f32_4x4x4_16b_bf16 v[40:43], v[2:3], v[78:79], v[40:43]
    v_mfma_f32_4x4x4_16b_bf16 v[44:47], v[2:3], v[80:81], v[44:47]
    v_mfma_f32_4x4x4_16b_bf16 v[48:51], v[2:3], v[82:83], v[48:51]
    buffer_load_dwordx4 v[68:71], v4, s[32:35], 0 offen sc1
    buffer_load_dwordx4 v[72:75], v5, s[32:35], 0 offen sc1
    buffer_load_dwordx4 v[76:79], v6, s[32:35], 0 offen sc1
    buffer_load_dwordx4 v[80:83], v7, s[32:35], 0 offen sc1
h_drain0:
    s_mov_b32 s79, 0
    s_branch h_drain
h_drain1:
    s_mov_b32 s79, 1
    s_branch h_drain
h_drain:
    s_cmp_lg_u32 s3, 7
    s_cbranch_scc1 h_rb
    v_mov_b32 v4, 157184
    v_mov_b32 v5, 1
    s_mov_b64 exec, 1
    ds_add_u32 v4, v5
    s_mov_b64 exec, -1
h_rb:
    s_cmp_ge_u32 s78, 8
    s_cbranch_scc1 h_rbd
    s_barrier
    s_add_u32 s78, s78, 1
    s_branch h_rb
h_rbd:
    s_cmp_eq_u32 s79, 1
    s_cbranch_scc1 h_dr1
    s_waitcnt vmcnt(6)
    v_mfma_f32_4x4x4_16b_bf16 v[36:39], v[2:3], v[52:53], v[36:39]
    v_mfma_f32_4x4x4_16b_bf16 v[40:43], v[2:3], v[54:55], v[40:43]
    v_mfma_f32_4x4x4_16b_bf16 v[44:47], v[2:3], v[56:57], v[44:47]
    v_mfma_f32_4x4x4_16b_bf16 v[48:51], v[2:3], v[58:59], v[48:51]
    s_waitcnt vmcnt(4)
    v_mfma_f32_4x4x4_16b_bf16 v[36:39], v[2:3], v[60:61], v[36:39]
    v_mfma_f32_4x4x4_16b_bf16 v[40:43], v[2:3], v[62:63], v[40:43]
    v_mfma_f32_4x4x4_16b_bf16 v[44:47], v[2:3], v[64:65], v[44:47]
    v_mfma_f32_4x4x4_16b_bf16 v[48:51], v[2:3], v[66:67], v[48:51]
    s_waitcnt vmcnt(2)
    v_mfma_f32_4x4x4_16b_bf16 v[36:39], v[2:3], v[68:69], v[36:39]
    v_mfma_f32_4x4x4_16b_bf16 v[40:43], v[2:3], v[70:71], v[40:43]
    v_mfma_f32_4x4x4_16b_bf16 v[44:47], v[2:3], v[72:73], v[44:47]
    v_mfma_f32_4x4x4_16b_bf16 v[48:51], v[2:3], v[74:75], v[48:51]
    s_waitcnt vmcnt(0)
    v_mfma_f32_4x4x4_16b_bf16 v[36:39], v[2:3], v[76:77], v[36:39]
    v_mfma_f32_4x4x4_16b_bf16 v[40:43], v[2:3], v[78:79], v[40:43]
    v_mfma_f32_4x4x4_16b_bf16 v[44:47], v[2:3], v[80:81], v[44:47]
    v_mfma_f32_4x4x4_16b_bf16 v[48:51], v[2:3], v[82:83], v[48:51]
    s_branch h_drx
h_dr1:
    s_waitcnt vmcnt(6)
    v_mfma_f32_4x4x4_16b_bf16 v[36:39], v[2:3], v[68:69], v[36:39]
    v_mfma_f32_4x4x4_16b_bf16 v[40:43], v[2:3], v[70:71], v[40:43]
    v_mfma_f32_4x4x4_16b_bf16 v[44:47], v[2:3], v[72:73], v[44:47]
    v_mfma_f32_4x4x4_16b_bf16 v[48:51], v[2:3], v[74:75], v[48:51]
    s_waitcnt vmcnt(4)
    v_mfma_f32_4x4x4_16b_bf16 v[36:39], v[2:3], v[76:77], v[36:39]
    v_mfma_f32_4x4x4_16b_bf16 v[40:43], v[2:3], v[78:79], v[40:43]
    v_mfma_f32_4x4x4_16b_bf16 v[44:47], v[2:3], v[80:81], v[44:47]
    v_mfma_f32_4x4x4_16b_bf16 v[48:51], v[2:3], v[82:83], v[48:51]
    s_waitcnt vmcnt(2)
    v_mfma_f32_4x4x4_16b_bf16 v[36:39], v[2:3], v[52:53], v[36:39]
    v_mfma_f32_4x4x4_16b_bf16 v[40:43], v[2:3], v[54:55], v[40:43]
    v_mfma_f32_4x4x4_16b_bf16 v[44:47], v[2:3], v[56:57], v[44:47]
    v_mfma_f32_4x4x4_16b_bf16 v[48:51], v[2:3], v[58:59], v[48:51]
    s_waitcnt vmcnt(0)
    v_mfma_f32_4x4x4_16b_bf16 v[36:39], v[2:3], v[60:61], v[36:39]
    v_mfma_f32_4x4x4_16b_bf16 v[40:43], v[2:3], v[62:63], v[40:43]
    v_mfma_f32_4x4x4_16b_bf16 v[44:47], v[2:3], v[64:65], v[44:47]
    v_mfma_f32_4x4x4_16b_bf16 v[48:51], v[2:3], v[66:67], v[48:51]
h_drx:
    s_cmp_gt_u32 s53, 40
    s_cbranch_scc1 h_slow
h_slow_r:
    s_nop 3
    s_cmp_eq_u32 s3, 7
    v_pk_mul_f32 v[36:37], v[36:37], v[12:13] op_sel:[0,0] op_sel_hi:[1,0]
    v_pk_mul_f32 v[38:39], v[38:39], v[12:13] op_sel:[0,0] op_sel_hi:[1,0]
    v_pk_mul_f32 v[40:41], v[40:41], v[12:13] op_sel:[0,0] op_sel_hi:[1,0]
    v_pk_mul_f32 v[42:43], v[42:43], v[12:13] op_sel:[0,0] op_sel_hi:[1,0]
    v_cvt_pk_bf16_f32 v36, v36, v37
    v_cvt_pk_bf16_f32 v37, v38, v39
    v_cvt_pk_bf16_f32 v38, v40, v41
    v_cvt_pk_bf16_f32 v39, v42, v43
    s_cbranch_scc1 h_ns0
    buffer_store_dwordx4 v[36:39], v8, s[36:39], 0 offen sc1
    buffer_store_dwordx4 v[36:39], v10, s[36:39], 0 offen sc1
h_ns0:
    v_pk_mul_f32 v[44:45], v[44:45], v[12:13] op_sel:[0,1] op_sel_hi:[1,1]
    v_pk_mul_f32 v[46:47], v[46:47], v[12:13] op_sel:[0,1] op_sel_hi:[1,1]
    v_pk_mul_f32 v[48:49], v[48:49], v[12:13] op_sel:[0,1] op_sel_hi:[1,1]
    v_pk_mul_f32 v[50:51], v[50:51], v[12:13] op_sel:[0,1] op_sel_hi:[1,1]
    v_cvt_pk_bf16_f32 v44, v44, v45
    v_cvt_pk_bf16_f32 v45, v46, v47
    v_cvt_pk_bf16_f32 v46, v48, v49
    v_cvt_pk_bf16_f32 v47, v50, v51
    s_cbranch_scc1 h_ns
    buffer_store_dwordx4 v[44:47], v9, s[36:39], 0 offen sc1
    buffer_store_dwordx4 v[44:47], v11, s[36:39], 0 offen sc1
    s_cmp_eq_u32 s3, 1
    s_cbranch_scc1 f_set
f_setr1:
    s_add_u32 s62, s62, 1
    v_mov_b32 v56, s56
    v_mov_b32 v57, 1
    s_lshl_b32 s64, s62, 5
    s_sub_u32 s64, s64, 1
    s_cmp_lg_u32 s4, 0
    s_waitcnt vmcnt(0)
    s_barrier
    s_cbranch_scc1 gb1_f
    s_mov_b64 exec, 1
    global_atomic_add v58, v56, v57, s[30:31] sc0 sc1
    s_waitcnt vmcnt(0)
    v_cmp_ne_u32 vcc, s64, v58
    s_cbranch_vccnz gb1_g
    s_mov_b64 exec, 0xff
    global_atomic_add v124, v57, s[30:31] sc1
    s_branch gb1_g
gb1_f:
    s_mov_b64 exec, 0xffff
    buffer_load_dword v127, v126, s[36:39], 0 offen sc1
gb1_g:
    s_mov_b64 exec, -1
h_ns:
    s_lshl_b32 s64, s3, 2
    s_sub_u32 s66, s3, 1
    s_mul_i32 s66, s66, 25344
    s_and_b32 s65, s3, 3
    s_lshl_b32 s65, s65, 6
    s_add_u32 s66, s66, s65
    s_lshr_b32 s65, s3, 2
    s_lshl_b32 s65, s65, 5
    s_add_u32 s66, s66, s65
    v_add_u32 v52, s64, v117
    v_add3_u32 v53, v1, v116, s66
    v_dot2_f32_bf16 v54, v36, s76, 0
    v_dot2_f32_bf16 v55, v36, v36, 0
    v_dot2_f32_bf16 v54, v37, s76, v54
    v_dot2_f32_bf16 v55, v37, v37, v55
    v_dot2_f32_bf16 v54, v38, s76, v54
    v_dot2_f32_bf16 v55, v38, v38, v55
    v_dot2_f32_bf16 v54, v39, s76, v54
    v_dot2_f32_bf16 v55, v39, v39, v55
    s_nop 2
    v_add_f32_dpp v54, v54, v54 quad_perm:[1,0,3,2] row_mask:0xf bank_mask:0xf
    v_add_f32_dpp v55, v55, v55 quad_perm:[1,0,3,2] row_mask:0xf bank_mask:0xf
    s_nop 0
    v_add_f32_dpp v54, v54, v54 quad_perm:[2,3,0,1] row_mask:0xf bank_mask:0xf
    v_add_f32_dpp v55, v55, v55 quad_perm:[2,3,0,1] row_mask:0xf bank_mask:0xf
    s_nop 0
    v_add_f32_dpp v54, v54, v54 row_half_mirror row_mask:0xf bank_mask:0xf
    v_add_f32_dpp v55, v55, v55 row_half_mirror row_mask:0xf bank_mask:0xf
    s_nop 0
    v_mul_f32 v54, 0x3c800000, v54
    v_mul_f32 v55, 0x3c800000, v55
    v_fma_f32 v55, -v54, v54, v55
    v_max_f32 v55, 0, v55
    v_mul_f32 v55, v14, v55
    v_mul_f32 v55, v14, v55
    v_add_f32 v55, 0x3727c5ac, v55
    v_rsq_f32 v54, v55
    s_nop 0
    v_mul_f32 v54, v14, v54
    s_mov_b64 exec, s[48:49]
    s_cbranch_execz ep5
    ds_write_b32 v52, v54 offset:0
    s_cmp_gt_u32 s3, 4
    s_cbranch_scc1 ep5
    ds_write_b128 v53, v[36:39] offset:0
ep5:
    s_mov_b64 exec, -1
    v_dot2_f32_bf16 v54, v44, s76, 0
    v_dot2_f32_bf16 v55, v44, v44, 0
    v_dot2_f32_bf16 v54, v45, s76, v54
    v_dot2_f32_bf16 v55, v45, v45, v55
    v_dot2_f32_bf16 v54, v46, s76, v54
    v_dot2_f32_bf16 v55, v46, v46, v55
    v_dot2_f32_bf16 v54, v47, s76, v54
    v_dot2_f32_bf16 v55, v47, v47, v55
    s_nop 2
    v_add_f32_dpp v54, v54, v54 quad_perm:[1,0,3,2] row_mask:0xf bank_mask:0xf
    v_add_f32_dpp v55, v55, v55 quad_perm:[1,0,3,2] row_mask:0xf bank_mask:0xf
    s_nop 0
    v_add_f32_dpp v54, v54, v54 quad_perm:[2,3,0,1] row_mask:0xf bank_mask:0xf
    v_add_f32_dpp v55, v55, v55 quad_perm:[2,3,0,1] row_mask:0xf bank_mask:0xf
    s_nop 0
    v_add_f32_dpp v54, v54, v54 row_half_mirror row_mask:0xf bank_mask:0xf
    v_add_f32_dpp v55, v55, v55 row_half_mirror row_mask:0xf bank_mask:0xf
    s_nop 0
    v_mul_f32 v54, 0x3c800000, v54
    v_mul_f32 v55, 0x3c800000, v55
    v_fma_f32 v55, -v54, v54, v55
    v_max_f32 v55, 0, v55
    v_mul_f32 v55, v15, v55
    v_mul_f32 v55, v15, v55
    v_add_f32 v55, 0x3727c5ac, v55
    v_rsq_f32 v54, v55
    s_nop 0
    v_mul_f32 v54, v15, v54
    s_mov_b64 exec, s[50:51]
    s_cbranch_execz ep7
    ds_write_b32 v52, v54 offset:256
    s_cmp_gt_u32 s3, 4
    s_cbranch_scc1 ep7
    ds_write_b128 v53, v[44:47] offset:1024
ep7:
    s_mov_b64 exec, -1
    s_cmp_eq_u32 s3, 7
    s_cbranch_scc1 f_top
    s_cmp_eq_u32 s3, 2
    s_cbranch_scc1 f_set2
    s_cmp_eq_u32 s3, 3
    s_cbranch_scc1 f_set3
f_setr:
    s_mov_b32 s32, s36
    s_mov_b32 s33, s37
    s_add_u32 s36, s36, 12582912
    s_addc_u32 s37, s37, 0
    s_add_u32 s3, s3, 1
    v_add_u32_dpp v4, v16, v1 quad_perm:[0,0,0,0] row_mask:0xf bank_mask:0xf
    v_add_u32_dpp v5, v26, v1 quad_perm:[0,0,0,0] row_mask:0xf bank_mask:0xf
    v_add_u32_dpp v6, v17, v1 quad_perm:[0,0,0,0] row_mask:0xf bank_mask:0xf
    v_add_u32_dpp v7, v27, v1 quad_perm:[0,0,0,0] row_mask:0xf bank_mask:0xf
    s_cmp_lg_u32 s4, 0
    s_cbranch_scc1 gb1_w
    v_mov_b32 v59, s57
    s_lshl_b32 s66, s62, 3
    s_mov_b32 s65, 0
    s_mov_b64 exec, 1
gb1_p:
    global_load_dword v58, v59, s[30:31] sc1
    s_add_u32 s65, s65, 1
    s_cmp_ge_u32 s65, 0x800000
    s_cbranch_scc1 gb1_pd
    s_waitcnt vmcnt(0)
    v_cmp_gt_u32 vcc, s66, v58
    s_cbranch_vccnz gb1_p
gb1_pd:
    s_mov_b64 exec, -1
gb1_w:
    s_barrier
    s_branch h_top
f_top:
    s_lshl_b32 s64, s2, 4
    s_add_u32 s64, s64, s4
    s_cmp_lg_u32 s64, 0xffc
    s_cbranch_scc1 h_nc
    v_mov_b32 v4, 0
    s_mov_b64 exec, 1
    global_store_dword v4, v4, s[28:29] sc1
    s_mov_b64 exec, -1
h_nc:
    s_mov_b32 exec_lo, 0x01010101
    s_mov_b32 exec_hi, 0x01010101
    buffer_load_dword v117, v118, s[44:47], 0 offen
    buffer_load_dword v117, v8, s[96:99], 0 offen sc1
    buffer_load_dword v117, v8, s[32:35], 0 offen sc1
    buffer_load_dword v117, v119, s[44:47], 0 offen
    buffer_load_dword v117, v9, s[96:99], 0 offen sc1
    buffer_load_dword v117, v9, s[32:35], 0 offen sc1
    s_mov_b64 exec, -1
    s_mov_b32 s36, s26
    s_mov_b32 s37, s27
    s_mov_b32 s38, 6400000
    s_mov_b32 s70, 0x000f000f
    s_mov_b32 s71, 0x000f000f
    s_mov_b32 s72, 0xffff
    s_mov_b32 s73, 0xffff
    v_mov_b32 v116, v125
f_loop:
    s_setprio 0
    s_mov_b32 exec_lo, -1
    s_mov_b32 exec_hi, 0
    ds_write_b128 v115, v[36:39] offset:1760
    s_mov_b64 exec, -1
    ds_read_b128 v[18:21], v104
    ds_read_b128 v[22:25], v104 offset:1024
    ds_read_b128 v[26:29], v104 offset:2048
    ds_read_b128 v[120:123], v106
    ds_read_b128 v[10:13], v116
    ds_read_b128 v[124:127], v106 offset:64
    ds_read_b128 v[14:17], v116 offset:64
    ds_read_b128 v[40:43], v106 offset:256
    ds_read_b128 v[48:51], v106 offset:320
    s_waitcnt lgkmcnt(4)
    v_mfma_f32_16x16x32_bf16 v[52:55], v[18:21], v[120:123], 0
    v_mfma_f32_16x16x32_bf16 v[68:71], v[18:21], v[10:13], 0
    ds_read_b128 v[18:21], v104 offset:3072
    s_waitcnt lgkmcnt(3)
    v_mfma_f32_16x16x32_bf16 v[52:55], v[22:25], v[124:127], v[52:55]
    v_mfma_f32_16x16x32_bf16 v[68:71], v[22:25], v[14:17], v[68:71]
    ds_read_b128 v[22:25], v104 offset:4096
    v_mfma_f32_16x16x32_bf16 v[56:59], v[26:29], v[120:123], 0
    v_mfma_f32_16x16x32_bf16 v[72:75], v[26:29], v[10:13], 0
    ds_read_b128 v[26:29], v104 offset:5120
    s_waitcnt lgkmcnt(2)
    v_mfma_f32_16x16x32_bf16 v[56:59], v[18:21], v[124:127], v[56:59]
    v_mfma_f32_16x16x32_bf16 v[72:75], v[18:21], v[14:17], v[72:75]
    ds_read_b128 v[18:21], v104 offset:6144
    s_waitcnt lgkmcnt(2)
    v_mfma_f32_16x16x32_bf16 v[60:63], v[22:25], v[120:123], 0
    v_mfma_f32_16x16x32_bf16 v[76:79], v[22:25], v[10:13], 0
    ds_read_b128 v[22:25], v104 offset:7168
    s_waitcnt lgkmcnt(2)
    v_mfma_f32_16x16x32_bf16 v[60:63], v[26:29], v[124:127], v[60:63]
    v_mfma_f32_16x16x32_bf16 v[76:79], v[26:29], v[14:17], v[76:79]
    ds_read_b128 v[26:29], v104 offset:8192
    v_cvt_pk_bf16_f32 v52, v52, v53
    v_cvt_pk_bf16_f32 v53, v54, v55
    v_cvt_pk_bf16_f32 v54, v56, v57
    v_cvt_pk_bf16_f32 v55, v58, v59
    v_cvt_pk_bf16_f32 v68, v68, v69
    v_cvt_pk_bf16_f32 v69, v70, v71
    v_cvt_pk_bf16_f32 v70, v72, v73
    v_cvt_pk_bf16_f32 v71, v74, v75
    s_waitcnt lgkmcnt(2)
    v_mfma_f32_16x16x32_bf16 v[64:67], v[18:21], v[120:123], 0
    v_mfma_f32_16x16x32_bf16 v[80:83], v[18:21], v[10:13], 0
    ds_read_b128 v[18:21], v104 offset:9216
    s_waitcnt lgkmcnt(2)
    v_mfma_f32_16x16x32_bf16 v[64:67], v[22:25], v[124:127], v[64:67]
    v_mfma_f32_16x16x32_bf16 v[80:83], v[22:25], v[14:17], v[80:83]
    ds_read_b128 v[22:25], v104 offset:12288
    v_mfma_f32_16x16x32_bf16 v[56:59], v[120:123], v[52:55], 0
    v_mfma_f32_16x16x32_bf16 v[72:75], v[40:43], v[68:71], 0
    ds_read_b128 v[14:17], v108 offset:0
    ds_read_b32 v4, v109 offset:0
    ds_read_b32 v5, v110 offset:0
    s_nop 0
    v_cvt_pk_bf16_f32 v60, v60, v61
    v_cvt_pk_bf16_f32 v61, v62, v63
    v_cvt_pk_bf16_f32 v62, v64, v65
    v_cvt_pk_bf16_f32 v63, v66, v67
    v_cvt_pk_bf16_f32 v76, v76, v77
    v_cvt_pk_bf16_f32 v77, v78, v79
    v_cvt_pk_bf16_f32 v78, v80, v81
    v_cvt_pk_bf16_f32 v79, v82, v83
    s_nop 0
    v_mfma_f32_16x16x32_bf16 v[56:59], v[124:127], v[60:63], v[56:59]
    v_mfma_f32_16x16x32_bf16 v[72:75], v[48:51], v[76:79], v[72:75]
    s_setprio 2
    s_waitcnt lgkmcnt(5)
    v_mfma_f32_16x16x32_bf16 v[52:55], v[120:123], v[26:29], 0
    v_mfma_f32_16x16x32_bf16 v[68:71], v[40:43], v[26:29], 0
    ds_read_b128 v[26:29], v104 offset:13312
    s_waitcnt lgkmcnt(5)
    v_mfma_f32_16x16x32_bf16 v[52:55], v[124:127], v[18:21], v[52:55]
    v_mfma_f32_16x16x32_bf16 v[68:71], v[48:51], v[18:21], v[68:71]
    ds_read_b128 v[18:21], v104 offset:14336
    s_waitcnt lgkmcnt(5)
    v_mfma_f32_16x16x32_bf16 v[60:63], v[120:123], v[22:25], 0
    v_mfma_f32_16x16x32_bf16 v[76:79], v[40:43], v[22:25], 0
    ds_read_b128 v[22:25], v104 offset:15360
    s_waitcnt lgkmcnt(3)
    s_mov_b64 exec, s[14:15]
    v_pk_mul_f32 v[10:11], v[56:57], v[14:15]
    v_pk_mul_f32 v[12:13], v[58:59], v[16:17]
    s_mov_b64 exec, s[16:17]
    v_pk_mul_f32 v[10:11], v[72:73], v[14:15]
    v_pk_mul_f32 v[12:13], v[74:75], v[16:17]
    s_mov_b64 exec, -1
    v_mul_f32 v4, s74, v4
    v_cndmask_b32 v5, v5, 1.0, s[18:19]
    v_max3_f32 v2, v10, v11, v12
    v_max_f32 v2, v2, v13
    v_mov_b32 v3, v2
    s_waitcnt lgkmcnt(2)
    v_mfma_f32_16x16x32_bf16 v[60:63], v[124:127], v[26:29], v[60:63]
    v_mfma_f32_16x16x32_bf16 v[76:79], v[48:51], v[26:29], v[76:79]
    ds_read_b128 v[26:29], v104 offset:10240
    v_permlane16_swap_b32 v2, v3
    v_max_f32 v2, v2, v3
    v_mul_f32 v2, v4, v2
    v_pk_fma_f32 v[10:11], v[10:11], v[4:5], v[2:3] op_sel_hi:[1,0,0] neg_lo:[0,0,1] neg_hi:[0,0,1]
    v_pk_fma_f32 v[12:13], v[12:13], v[4:5], v[2:3] op_sel_hi:[1,0,0] neg_lo:[0,0,1] neg_hi:[0,0,1]
    v_exp_f32 v10, v10
    v_exp_f32 v11, v11
    v_exp_f32 v12, v12
    v_exp_f32 v13, v13
    s_waitcnt lgkmcnt(2)
    v_mfma_f32_16x16x32_bf16 v[64:67], v[120:123], v[18:21], 0
    v_mfma_f32_16x16x32_bf16 v[80:83], v[40:43], v[18:21], 0
    ds_read_b128 v[18:21], v104 offset:11264
    v_add_f32 v2, v10, v11
    v_add_f32 v3, v12, v13
    v_add_f32 v2, v2, v3
    v_mov_b32 v3, v2
    v_pk_mul_f32 v[10:11], v[10:11], v[14:15]
    v_pk_mul_f32 v[12:13], v[12:13], v[16:17]
    s_waitcnt lgkmcnt(2)
    v_mfma_f32_16x16x32_bf16 v[64:67], v[124:127], v[22:25], v[64:67]
    v_mfma_f32_16x16x32_bf16 v[80:83], v[48:51], v[22:25], v[80:83]
    v_permlane16_swap_b32 v2, v3
    v_add_f32 v2, v2, v3
    v_rcp_f32 v2, v2
    v_cvt_pk_bf16_f32 v55, v54, v55
    v_cvt_pk_bf16_f32 v54, v52, v53
    ds_read_b64_tr_b16 v[52:53], v107 offset:0
    v_cvt_pk_bf16_f32 v71, v70, v71
    v_cvt_pk_bf16_f32 v70, v68, v69
    ds_read_b64_tr_b16 v[68:69], v107 offset:256
    v_mul_f32 v2, v5, v2
    v_pk_mul_f32 v[10:11], v[10:11], v[2:3] op_sel_hi:[1,0]
    v_pk_mul_f32 v[12:13], v[12:13], v[2:3] op_sel_hi:[1,0]
    s_waitcnt lgkmcnt(3)
    v_mfma_f32_16x16x32_bf16 v[56:59], v[120:123], v[26:29], 0
    v_mfma_f32_16x16x32_bf16 v[72:75], v[40:43], v[26:29], 0
    s_mov_b64 exec, s[14:15]
    v_cvt_pk_bf16_f32 v94, v10, v11
    v_cvt_pk_bf16_f32 v95, v12, v13
    s_mov_b64 exec, s[16:17]
    v_cvt_pk_bf16_f32 v98, v10, v11
    v_cvt_pk_bf16_f32 v99, v12, v13
    s_mov_b64 exec, -1
    v_cvt_pk_bf16_f32 v63, v62, v63
    v_cvt_pk_bf16_f32 v62, v60, v61
    ds_read_b64_tr_b16 v[60:61], v107 offset:64
    v_cvt_pk_bf16_f32 v79, v78, v79
    v_cvt_pk_bf16_f32 v78, v76, v77
    ds_read_b64_tr_b16 v[76:77], v107 offset:320
    s_waitcnt lgkmcnt(4)
    v_mfma_f32_16x16x32_bf16 v[56:59], v[124:127], v[18:21], v[56:59]
    v_mfma_f32_16x16x32_bf16 v[72:75], v[48:51], v[18:21], v[72:75]
    v_cvt_pk_bf16_f32 v67, v66, v67
    v_cvt_pk_bf16_f32 v66, v64, v65
    ds_read_b64_tr_b16 v[64:65], v107 offset:72
    v_cvt_pk_bf16_f32 v83, v82, v83
    v_cvt_pk_bf16_f32 v82, v80, v81
    ds_read_b64_tr_b16 v[80:81], v107 offset:328
    ds_read_b32 v6, v111 offset:4
    ds_read_b32 v7, v114 offset:8
    v_cvt_pk_bf16_f32 v59, v58, v59
    v_cvt_pk_bf16_f32 v58, v56, v57
    ds_read_b64_tr_b16 v[56:57], v107 offset:8
    v_cvt_pk_bf16_f32 v75, v74, v75
    v_cvt_pk_bf16_f32 v74, v72, v73
    ds_read_b64_tr_b16 v[72:73], v107 offset:264
    s_setprio 1
    s_waitcnt lgkmcnt(9)
    v_mfma_f32_16x16x32_bf16 v[10:13], v[52:55], v[92:95], 0
    s_waitcnt lgkmcnt(7)
    v_mfma_f32_16x16x32_bf16 v[18:21], v[60:63], v[92:95], 0
    s_waitcnt lgkmcnt(5)
    v_mfma_f32_16x16x32_bf16 v[22:25], v[64:67], v[92:95], 0
    s_waitcnt lgkmcnt(1)
    v_mfma_f32_16x16x32_bf16 v[14:17], v[56:59], v[92:95], 0
    v_mfma_f32_16x16x32_bf16 v[52:55], v[68:71], v[96:99], 0
    v_mfma_f32_16x16x32_bf16 v[60:63], v[76:79], v[96:99], 0
    v_mfma_f32_16x16x32_bf16 v[64:67], v[80:83], v[96:99], 0
    s_waitcnt lgkmcnt(0)
    v_mfma_f32_16x16x32_bf16 v[56:59], v[72:75], v[96:99], 0
    v_cndmask_b32 v6, v6, 1.0, s[18:19]
    v_add_u32 v7, v7, v105
    v_cvt_pk_bf16_f32 v120, v10, v11
    v_cvt_pk_bf16_f32 v121, v12, v13
    v_cvt_pk_bf16_f32 v124, v18, v19
    v_cvt_pk_bf16_f32 v125, v20, v21
    v_cvt_pk_bf16_f32 v126, v22, v23
    v_cvt_pk_bf16_f32 v127, v24, v25
    v_cvt_pk_bf16_f32 v122, v14, v15
    v_cvt_pk_bf16_f32 v123, v16, v17
    ds_write_b128 v106, v[120:123]
    ds_write_b128 v106, v[124:127] offset:64
    v_cvt_pk_bf16_f32 v40, v52, v53
    v_cvt_pk_bf16_f32 v41, v54, v55
    v_cvt_pk_bf16_f32 v48, v60, v61
    v_cvt_pk_bf16_f32 v49, v62, v63
    v_cvt_pk_bf16_f32 v50, v64, v65
    v_cvt_pk_bf16_f32 v51, v66, v67
    v_cvt_pk_bf16_f32 v42, v56, v57
    v_cvt_pk_bf16_f32 v43, v58, v59
    ds_write_b128 v116, v[40:43]
    ds_write_b128 v116, v[48:51] offset:64
    v_mfma_f32_16x16x32_bf16 v[68:71], v[84:87], v[120:123], 0
    v_mfma_f32_16x16x32_bf16 v[72:75], v[84:87], v[40:43], 0
    v_mfma_f32_16x16x32_bf16 v[68:71], v[88:91], v[124:127], v[68:71]
    v_mfma_f32_16x16x32_bf16 v[72:75], v[88:91], v[48:51], v[72:75]
    ds_read_b64_tr_b16 v[10:11], v107 offset:0
    ds_read_b64_tr_b16 v[12:13], v107 offset:256
    ds_read_b64_tr_b16 v[14:15], v107 offset:8
    ds_read_b64_tr_b16 v[16:17], v107 offset:264
    ds_read_b64_tr_b16 v[18:19], v107 offset:64
    ds_read_b64_tr_b16 v[20:21], v107 offset:320
    ds_read_b64_tr_b16 v[22:23], v107 offset:72
    ds_read_b64_tr_b16 v[24:25], v107 offset:328
    s_setprio 0
    v_dot2_f32_bf16 v80, v120, v120, 0
    v_dot2_f32_bf16 v81, v40, v40, 0
    v_dot2_f32_bf16 v80, v121, v121, v80
    v_dot2_f32_bf16 v81, v41, v41, v81
    v_dot2_f32_bf16 v80, v122, v122, v80
    v_dot2_f32_bf16 v81, v42, v42, v81
    v_dot2_f32_bf16 v80, v123, v123, v80
    v_dot2_f32_bf16 v81, v43, v43, v81
    v_dot2_f32_bf16 v80, v124, v124, v80
    v_dot2_f32_bf16 v81, v48, v48, v81
    v_dot2_f32_bf16 v80, v125, v125, v80
    v_dot2_f32_bf16 v81, v49, v49, v81
    v_dot2_f32_bf16 v80, v126, v126, v80
    v_dot2_f32_bf16 v81, v50, v50, v81
    v_dot2_f32_bf16 v80, v127, v127, v80
    v_dot2_f32_bf16 v81, v51, v51, v81
    v_cndmask_b32 v68, v72, v68, s[20:21]
    v_cndmask_b32 v69, v73, v69, s[20:21]
    v_mul_f32 v82, 0x3e000000, v68
    v_permlane32_swap_b32 v80, v81
    v_add_f32 v80, v80, v81
    v_mov_b32 v81, v80
    v_fma_f32 v83, -v68, s55, v69
    v_mul_f32 v68, 0x3e000000, v6
    v_permlane16_swap_b32 v80, v81
    s_mov_b64 exec, s[72:73]
    v_add_f32 v80, v80, v81
    v_mul_f32 v68, v68, v68
    v_fma_f32 v80, -v82, v82, v80
    v_max_f32 v80, 0, v80
    v_fmaak_f32 v80, v68, v80, 0x3727c5ac
    v_rsq_f32 v80, v80
    v_mul_f32 v83, v6, v83
    v_mul_f32 v83, 0x3fb8aa3b, v83
    v_mul_f32 v80, v80, v83
    s_mov_b64 exec, s[10:11]
    v_add_u32 v106, 0x200, v106
    v_add_u32 v116, 0x200, v116
    s_mov_b64 exec, s[72:73]
    v_max_f32_dpp v81, v80, v80 quad_perm:[1,0,3,2] row_mask:0xf bank_mask:0xf
    s_nop 1
    v_max_f32_dpp v81, v81, v81 quad_perm:[2,3,0,1] row_mask:0xf bank_mask:0xf
    s_nop 1
    v_max_f32_dpp v81, v81, v81 row_half_mirror row_mask:0xf bank_mask:0xf
    v_sub_f32 v80, v80, v81
    v_exp_f32 v80, v80
    s_mov_b64 exec, s[12:13]
    v_add_u32 v107, 0x200, v107
    s_mov_b64 exec, s[72:73]
    v_add_f32_dpp v81, v80, v80 quad_perm:[1,0,3,2] row_mask:0xf bank_mask:0xf
    s_nop 1
    v_add_f32_dpp v81, v81, v81 quad_perm:[2,3,0,1] row_mask:0xf bank_mask:0xf
    s_nop 1
    v_add_f32_dpp v81, v81, v81 row_half_mirror row_mask:0xf bank_mask:0xf
    v_rcp_f32 v81, v81
    v_mul_f32 v80, v6, v80
    v_mul_f32 v80, v80, v81
    ds_write_b32 v112, v80 offset:0
    s_mov_b64 exec, -1
    ds_read_b128 v[68:71], v113 offset:0
    s_waitcnt lgkmcnt(2)
    s_cmp_eq_u32 s4, 12
    s_cbranch_scc1 f_nd0
    s_mov_b32 exec_lo, 0
    s_mov_b32 exec_hi, -1
    s_sub_u32 m0, s95, 512
    s_nop 0
    buffer_load_dwordx4 v118, s[44:47], 0 offen  lds
    s_add_u32 m0, s95, 96
    s_nop 0
    buffer_load_dwordx4 v8, s[96:99], 0 offen sc1 lds
    s_add_u32 m0, s95, 672
    s_nop 0
    buffer_load_dwordx4 v8, s[32:35], 0 offen sc1 lds
    s_mov_b64 exec, -1
f_nd0:
    s_setprio 0
    s_waitcnt lgkmcnt(0)
    s_mov_b64 exec, s[22:23]
    v_cvt_pk_bf16_f32 v100, v68, v69
    v_cvt_pk_bf16_f32 v101, v70, v71
    s_mov_b64 exec, s[8:9]
    v_cvt_pk_bf16_f32 v102, v68, v69
    v_cvt_pk_bf16_f32 v103, v70, v71
    s_mov_b64 exec, -1
    s_nop 0
    v_mfma_f32_16x16x32_bf16 v[52:55], v[10:13], v[100:103], 0
    v_mfma_f32_16x16x32_bf16 v[56:59], v[14:17], v[100:103], 0
    v_mfma_f32_16x16x32_bf16 v[60:63], v[18:21], v[100:103], 0
    v_mfma_f32_16x16x32_bf16 v[64:67], v[22:25], v[100:103], 0
    s_mov_b64 exec, s[70:71]
    s_nop 3
    v_cvt_pk_bf16_f32 v76, v52, v53
    v_cvt_pk_bf16_f32 v77, v54, v55
    v_cvt_pk_bf16_f32 v78, v56, v57
    v_cvt_pk_bf16_f32 v79, v58, v59
    v_cvt_pk_bf16_f32 v80, v60, v61
    v_cvt_pk_bf16_f32 v81, v62, v63
    v_cvt_pk_bf16_f32 v82, v64, v65
    v_cvt_pk_bf16_f32 v83, v66, v67
    buffer_store_dwordx4 v[76:79], v7, s[36:39], 0 offen sc1
    buffer_store_dwordx4 v[80:83], v7, s[36:39], 0 offen offset:64 sc1
    s_mov_b64 exec, -1
    s_cmp_eq_u32 s4, 12
    s_cbranch_scc1 f_done
    s_setprio 0
    s_mov_b32 exec_lo, 0
    s_mov_b32 exec_hi, -1
    ds_write_b128 v115, v[36:39] offset:1760
    s_mov_b64 exec, -1
    ds_read_b128 v[18:21], v104
    ds_read_b128 v[22:25], v104 offset:1024
    ds_read_b128 v[26:29], v104 offset:2048
    s_waitcnt vmcnt(2)
    ds_read_b128 v[120:123], v106
    ds_read_b128 v[10:13], v116
    ds_read_b128 v[124:127], v106 offset:64
    ds_read_b128 v[14:17], v116 offset:64
    ds_read_b128 v[40:43], v106 offset:256
    ds_read_b128 v[48:51], v106 offset:320
    s_waitcnt lgkmcnt(4)
    v_mfma_f32_16x16x32_bf16 v[52:55], v[18:21], v[120:123], 0
    v_mfma_f32_16x16x32_bf16 v[68:71], v[18:21], v[10:13], 0
    ds_read_b128 v[18:21], v104 offset:3072
    s_waitcnt lgkmcnt(3)
    v_mfma_f32_16x16x32_bf16 v[52:55], v[22:25], v[124:127], v[52:55]
    v_mfma_f32_16x16x32_bf16 v[68:71], v[22:25], v[14:17], v[68:71]
    ds_read_b128 v[22:25], v104 offset:4096
    v_mfma_f32_16x16x32_bf16 v[56:59], v[26:29], v[120:123], 0
    v_mfma_f32_16x16x32_bf16 v[72:75], v[26:29], v[10:13], 0
    ds_read_b128 v[26:29], v104 offset:5120
    s_waitcnt lgkmcnt(2)
    v_mfma_f32_16x16x32_bf16 v[56:59], v[18:21], v[124:127], v[56:59]
    v_mfma_f32_16x16x32_bf16 v[72:75], v[18:21], v[14:17], v[72:75]
    ds_read_b128 v[18:21], v104 offset:6144
    s_waitcnt lgkmcnt(2)
    v_mfma_f32_16x16x32_bf16 v[60:63], v[22:25], v[120:123], 0
    v_mfma_f32_16x16x32_bf16 v[76:79], v[22:25], v[10:13], 0
    ds_read_b128 v[22:25], v104 offset:7168
    s_waitcnt lgkmcnt(2)
    v_mfma_f32_16x16x32_bf16 v[60:63], v[26:29], v[124:127], v[60:63]
    v_mfma_f32_16x16x32_bf16 v[76:79], v[26:29], v[14:17], v[76:79]
    ds_read_b128 v[26:29], v104 offset:8192
    v_cvt_pk_bf16_f32 v52, v52, v53
    v_cvt_pk_bf16_f32 v53, v54, v55
    v_cvt_pk_bf16_f32 v54, v56, v57
    v_cvt_pk_bf16_f32 v55, v58, v59
    v_cvt_pk_bf16_f32 v68, v68, v69
    v_cvt_pk_bf16_f32 v69, v70, v71
    v_cvt_pk_bf16_f32 v70, v72, v73
    v_cvt_pk_bf16_f32 v71, v74, v75
    s_waitcnt lgkmcnt(2)
    v_mfma_f32_16x16x32_bf16 v[64:67], v[18:21], v[120:123], 0
    v_mfma_f32_16x16x32_bf16 v[80:83], v[18:21], v[10:13], 0
    ds_read_b128 v[18:21], v104 offset:9216
    s_waitcnt lgkmcnt(2)
    v_mfma_f32_16x16x32_bf16 v[64:67], v[22:25], v[124:127], v[64:67]
    v_mfma_f32_16x16x32_bf16 v[80:83], v[22:25], v[14:17], v[80:83]
    ds_read_b128 v[22:25], v104 offset:12288
    v_mfma_f32_16x16x32_bf16 v[56:59], v[120:123], v[52:55], 0
    v_mfma_f32_16x16x32_bf16 v[72:75], v[40:43], v[68:71], 0
    ds_read_b128 v[14:17], v108 offset:128
    ds_read_b32 v4, v109 offset:128
    ds_read_b32 v5, v110 offset:64
    s_nop 0
    v_cvt_pk_bf16_f32 v60, v60, v61
    v_cvt_pk_bf16_f32 v61, v62, v63
    v_cvt_pk_bf16_f32 v62, v64, v65
    v_cvt_pk_bf16_f32 v63, v66, v67
    v_cvt_pk_bf16_f32 v76, v76, v77
    v_cvt_pk_bf16_f32 v77, v78, v79
    v_cvt_pk_bf16_f32 v78, v80, v81
    v_cvt_pk_bf16_f32 v79, v82, v83
    s_nop 0
    v_mfma_f32_16x16x32_bf16 v[56:59], v[124:127], v[60:63], v[56:59]
    v_mfma_f32_16x16x32_bf16 v[72:75], v[48:51], v[76:79], v[72:75]
    s_setprio 2
    s_waitcnt lgkmcnt(5)
    v_mfma_f32_16x16x32_bf16 v[52:55], v[120:123], v[26:29], 0
    v_mfma_f32_16x16x32_bf16 v[68:71], v[40:43], v[26:29], 0
    ds_read_b128 v[26:29], v104 offset:13312
    s_waitcnt lgkmcnt(5)
    v_mfma_f32_16x16x32_bf16 v[52:55], v[124:127], v[18:21], v[52:55]
    v_mfma_f32_16x16x32_bf16 v[68:71], v[48:51], v[18:21], v[68:71]
    ds_read_b128 v[18:21], v104 offset:14336
    s_waitcnt lgkmcnt(5)
    v_mfma_f32_16x16x32_bf16 v[60:63], v[120:123], v[22:25], 0
    v_mfma_f32_16x16x32_bf16 v[76:79], v[40:43], v[22:25], 0
    ds_read_b128 v[22:25], v104 offset:15360
    s_waitcnt lgkmcnt(3)
    s_mov_b64 exec, s[14:15]
    v_pk_mul_f32 v[10:11], v[56:57], v[14:15]
    v_pk_mul_f32 v[12:13], v[58:59], v[16:17]
    s_mov_b64 exec, s[16:17]
    v_pk_mul_f32 v[10:11], v[72:73], v[14:15]
    v_pk_mul_f32 v[12:13], v[74:75], v[16:17]
    s_mov_b64 exec, -1
    v_mul_f32 v4, s74, v4
    v_cndmask_b32 v5, v5, 1.0, s[18:19]
    v_max3_f32 v2, v10, v11, v12
    v_max_f32 v2, v2, v13
    v_mov_b32 v3, v2
    s_waitcnt lgkmcnt(2)
    v_mfma_f32_16x16x32_bf16 v[60:63], v[124:127], v[26:29], v[60:63]
    v_mfma_f32_16x16x32_bf16 v[76:79], v[48:51], v[26:29], v[76:79]
    ds_read_b128 v[26:29], v104 offset:10240
    v_permlane16_swap_b32 v2, v3
    v_max_f32 v2, v2, v3
    v_mul_f32 v2, v4, v2
    v_pk_fma_f32 v[10:11], v[10:11], v[4:5], v[2:3] op_sel_hi:[1,0,0] neg_lo:[0,0,1] neg_hi:[0,0,1]
    v_pk_fma_f32 v[12:13], v[12:13], v[4:5], v[2:3] op_sel_hi:[1,0,0] neg_lo:[0,0,1] neg_hi:[0,0,1]
    v_exp_f32 v10, v10
    v_exp_f32 v11, v11
    v_exp_f32 v12, v12
    v_exp_f32 v13, v13
    s_waitcnt lgkmcnt(2)
    v_mfma_f32_16x16x32_bf16 v[64:67], v[120:123], v[18:21], 0
    v_mfma_f32_16x16x32_bf16 v[80:83], v[40:43], v[18:21], 0
    ds_read_b128 v[18:21], v104 offset:11264
    v_add_f32 v2, v10, v11
    v_add_f32 v3, v12, v13
    v_add_f32 v2, v2, v3
    v_mov_b32 v3, v2
    v_pk_mul_f32 v[10:11], v[10:11], v[14:15]
    v_pk_mul_f32 v[12:13], v[12:13], v[16:17]
    s_waitcnt lgkmcnt(2)
    v_mfma_f32_16x16x32_bf16 v[64:67], v[124:127], v[22:25], v[64:67]
    v_mfma_f32_16x16x32_bf16 v[80:83], v[48:51], v[22:25], v[80:83]
    v_permlane16_swap_b32 v2, v3
    v_add_f32 v2, v2, v3
    v_rcp_f32 v2, v2
    v_cvt_pk_bf16_f32 v55, v54, v55
    v_cvt_pk_bf16_f32 v54, v52, v53
    ds_read_b64_tr_b16 v[52:53], v107 offset:0
    v_cvt_pk_bf16_f32 v71, v70, v71
    v_cvt_pk_bf16_f32 v70, v68, v69
    ds_read_b64_tr_b16 v[68:69], v107 offset:256
    v_mul_f32 v2, v5, v2
    v_pk_mul_f32 v[10:11], v[10:11], v[2:3] op_sel_hi:[1,0]
    v_pk_mul_f32 v[12:13], v[12:13], v[2:3] op_sel_hi:[1,0]
    s_waitcnt lgkmcnt(3)
    v_mfma_f32_16x16x32_bf16 v[56:59], v[120:123], v[26:29], 0
    v_mfma_f32_16x16x32_bf16 v[72:75], v[40:43], v[26:29], 0
    s_mov_b64 exec, s[14:15]
    v_cvt_pk_bf16_f32 v94, v10, v11
    v_cvt_pk_bf16_f32 v95, v12, v13
    s_mov_b64 exec, s[16:17]
    v_cvt_pk_bf16_f32 v98, v10, v11
    v_cvt_pk_bf16_f32 v99, v12, v13
    s_mov_b64 exec, -1
    v_cvt_pk_bf16_f32 v63, v62, v63
    v_cvt_pk_bf16_f32 v62, v60, v61
    ds_read_b64_tr_b16 v[60:61], v107 offset:64
    v_cvt_pk_bf16_f32 v79, v78, v79
    v_cvt_pk_bf16_f32 v78, v76, v77
    ds_read_b64_tr_b16 v[76:77], v107 offset:320
    s_waitcnt lgkmcnt(4)
    v_mfma_f32_16x16x32_bf16 v[56:59], v[124:127], v[18:21], v[56:59]
    v_mfma_f32_16x16x32_bf16 v[72:75], v[48:51], v[18:21], v[72:75]
    v_cvt_pk_bf16_f32 v67, v66, v67
    v_cvt_pk_bf16_f32 v66, v64, v65
    ds_read_b64_tr_b16 v[64:65], v107 offset:72
    v_cvt_pk_bf16_f32 v83, v82, v83
    v_cvt_pk_bf16_f32 v82, v80, v81
    ds_read_b64_tr_b16 v[80:81], v107 offset:328
    ds_read_b32 v6, v111 offset:68
    ds_read_b32 v7, v114 offset:72
    v_cvt_pk_bf16_f32 v59, v58, v59
    v_cvt_pk_bf16_f32 v58, v56, v57
    ds_read_b64_tr_b16 v[56:57], v107 offset:8
    v_cvt_pk_bf16_f32 v75, v74, v75
    v_cvt_pk_bf16_f32 v74, v72, v73
    ds_read_b64_tr_b16 v[72:73], v107 offset:264
    s_setprio 1
    s_waitcnt lgkmcnt(9)
    v_mfma_f32_16x16x32_bf16 v[10:13], v[52:55], v[92:95], 0
    s_waitcnt lgkmcnt(7)
    v_mfma_f32_16x16x32_bf16 v[18:21], v[60:63], v[92:95], 0
    s_waitcnt lgkmcnt(5)
    v_mfma_f32_16x16x32_bf16 v[22:25], v[64:67], v[92:95], 0
    s_waitcnt lgkmcnt(1)
    v_mfma_f32_16x16x32_bf16 v[14:17], v[56:59], v[92:95], 0
    v_mfma_f32_16x16x32_bf16 v[52:55], v[68:71], v[96:99], 0
    v_mfma_f32_16x16x32_bf16 v[60:63], v[76:79], v[96:99], 0
    v_mfma_f32_16x16x32_bf16 v[64:67], v[80:83], v[96:99], 0
    s_waitcnt lgkmcnt(0)
    v_mfma_f32_16x16x32_bf16 v[56:59], v[72:75], v[96:99], 0
    v_cndmask_b32 v6, v6, 1.0, s[18:19]
    v_add_u32 v7, v7, v105
    v_cvt_pk_bf16_f32 v120, v10, v11
    v_cvt_pk_bf16_f32 v121, v12, v13
    v_cvt_pk_bf16_f32 v124, v18, v19
    v_cvt_pk_bf16_f32 v125, v20, v21
    v_cvt_pk_bf16_f32 v126, v22, v23
    v_cvt_pk_bf16_f32 v127, v24, v25
    v_cvt_pk_bf16_f32 v122, v14, v15
    v_cvt_pk_bf16_f32 v123, v16, v17
    ds_write_b128 v106, v[120:123]
    ds_write_b128 v106, v[124:127] offset:64
    v_cvt_pk_bf16_f32 v40, v52, v53
    v_cvt_pk_bf16_f32 v41, v54, v55
    v_cvt_pk_bf16_f32 v48, v60, v61
    v_cvt_pk_bf16_f32 v49, v62, v63
    v_cvt_pk_bf16_f32 v50, v64, v65
    v_cvt_pk_bf16_f32 v51, v66, v67
    v_cvt_pk_bf16_f32 v42, v56, v57
    v_cvt_pk_bf16_f32 v43, v58, v59
    ds_write_b128 v116, v[40:43]
    ds_write_b128 v116, v[48:51] offset:64
    v_mfma_f32_16x16x32_bf16 v[68:71], v[84:87], v[120:123], 0
    v_mfma_f32_16x16x32_bf16 v[72:75], v[84:87], v[40:43], 0
    v_mfma_f32_16x16x32_bf16 v[68:71], v[88:91], v[124:127], v[68:71]
    v_mfma_f32_16x16x32_bf16 v[72:75], v[88:91], v[48:51], v[72:75]
    ds_read_b64_tr_b16 v[10:11], v107 offset:0
    ds_read_b64_tr_b16 v[12:13], v107 offset:256
    ds_read_b64_tr_b16 v[14:15], v107 offset:8
    ds_read_b64_tr_b16 v[16:17], v107 offset:264
    ds_read_b64_tr_b16 v[18:19], v107 offset:64
    ds_read_b64_tr_b16 v[20:21], v107 offset:320
    ds_read_b64_tr_b16 v[22:23], v107 offset:72
    ds_read_b64_tr_b16 v[24:25], v107 offset:328
    s_setprio 0
    v_dot2_f32_bf16 v80, v120, v120, 0
    v_dot2_f32_bf16 v81, v40, v40, 0
    v_dot2_f32_bf16 v80, v121, v121, v80
    v_dot2_f32_bf16 v81, v41, v41, v81
    v_dot2_f32_bf16 v80, v122, v122, v80
    v_dot2_f32_bf16 v81, v42, v42, v81
    v_dot2_f32_bf16 v80, v123, v123, v80
    v_dot2_f32_bf16 v81, v43, v43, v81
    v_dot2_f32_bf16 v80, v124, v124, v80
    v_dot2_f32_bf16 v81, v48, v48, v81
    v_dot2_f32_bf16 v80, v125, v125, v80
    v_dot2_f32_bf16 v81, v49, v49, v81
    v_dot2_f32_bf16 v80, v126, v126, v80
    v_dot2_f32_bf16 v81, v50, v50, v81
    v_dot2_f32_bf16 v80, v127, v127, v80
    v_dot2_f32_bf16 v81, v51, v51, v81
    v_cndmask_b32 v68, v72, v68, s[20:21]
    v_cndmask_b32 v69, v73, v69, s[20:21]
    v_mul_f32 v82, 0x3e000000, v68
    v_permlane32_swap_b32 v80, v81
    v_add_f32 v80, v80, v81
    v_mov_b32 v81, v80
    v_fma_f32 v83, -v68, s55, v69
    v_mul_f32 v68, 0x3e000000, v6
    v_permlane16_swap_b32 v80, v81
    s_mov_b64 exec, s[72:73]
    v_add_f32 v80, v80, v81
    v_mul_f32 v68, v68, v68
    v_fma_f32 v80, -v82, v82, v80
    v_max_f32 v80, 0, v80
    v_fmaak_f32 v80, v68, v80, 0x3727c5ac
    v_rsq_f32 v80, v80
    v_mul_f32 v83, v6, v83
    v_mul_f32 v83, 0x3fb8aa3b, v83
    v_mul_f32 v80, v80, v83
    s_mov_b64 exec, s[10:11]
    v_add_u32 v106, 0x200, v106
    v_add_u32 v116, 0x200, v116
    s_mov_b64 exec, s[72:73]
    v_max_f32_dpp v81, v80, v80 quad_perm:[1,0,3,2] row_mask:0xf bank_mask:0xf
    s_nop 1
    v_max_f32_dpp v81, v81, v81 quad_perm:[2,3,0,1] row_mask:0xf bank_mask:0xf
    s_nop 1
    v_max_f32_dpp v81, v81, v81 row_half_mirror row_mask:0xf bank_mask:0xf
    v_sub_f32 v80, v80, v81
    v_exp_f32 v80, v80
    s_mov_b64 exec, s[12:13]
    v_add_u32 v107, 0x200, v107
    s_mov_b64 exec, s[72:73]
    v_add_f32_dpp v81, v80, v80 quad_perm:[1,0,3,2] row_mask:0xf bank_mask:0xf
    s_nop 1
    v_add_f32_dpp v81, v81, v81 quad_perm:[2,3,0,1] row_mask:0xf bank_mask:0xf
    s_nop 1
    v_add_f32_dpp v81, v81, v81 row_half_mirror row_mask:0xf bank_mask:0xf
    v_rcp_f32 v81, v81
    v_mul_f32 v80, v6, v80
    v_mul_f32 v80, v80, v81
    ds_write_b32 v112, v80 offset:128
    s_mov_b64 exec, -1
    ds_read_b128 v[68:71], v113 offset:128
    s_waitcnt lgkmcnt(2)
    s_mov_b32 exec_lo, -1
    s_mov_b32 exec_hi, 0
    s_add_u32 m0, s95, 0
    s_nop 0
    buffer_load_dwordx4 v119, s[44:47], 0 offen  lds
    s_add_u32 m0, s95, 608
    s_nop 0
    buffer_load_dwordx4 v9, s[96:99], 0 offen sc1 lds
    s_add_u32 m0, s95, 1184
    s_nop 0
    buffer_load_dwordx4 v9, s[32:35], 0 offen sc1 lds
    s_mov_b64 exec, -1
    s_setprio 0
    s_waitcnt lgkmcnt(0)
    s_mov_b64 exec, s[22:23]
    v_cvt_pk_bf16_f32 v100, v68, v69
    v_cvt_pk_bf16_f32 v101, v70, v71
    s_mov_b64 exec, s[8:9]
    v_cvt_pk_bf16_f32 v102, v68, v69
    v_cvt_pk_bf16_f32 v103, v70, v71
    s_mov_b64 exec, -1
    s_nop 0
    v_mfma_f32_16x16x32_bf16 v[52:55], v[10:13], v[100:103], 0
    v_mfma_f32_16x16x32_bf16 v[56:59], v[14:17], v[100:103], 0
    v_mfma_f32_16x16x32_bf16 v[60:63], v[18:21], v[100:103], 0
    v_mfma_f32_16x16x32_bf16 v[64:67], v[22:25], v[100:103], 0
    s_mov_b64 exec, s[70:71]
    s_nop 3
    v_cvt_pk_bf16_f32 v76, v52, v53
    v_cvt_pk_bf16_f32 v77, v54, v55
    v_cvt_pk_bf16_f32 v78, v56, v57
    v_cvt_pk_bf16_f32 v79, v58, v59
    v_cvt_pk_bf16_f32 v80, v60, v61
    v_cvt_pk_bf16_f32 v81, v62, v63
    v_cvt_pk_bf16_f32 v82, v64, v65
    v_cvt_pk_bf16_f32 v83, v66, v67
    buffer_store_dwordx4 v[76:79], v7, s[36:39], 0 offen sc1
    buffer_store_dwordx4 v[80:83], v7, s[36:39], 0 offen offset:64 sc1
    s_mov_b64 exec, -1
    s_setprio 0
    s_mov_b32 exec_lo, -1
    s_mov_b32 exec_hi, 0
    ds_write_b128 v115, v[44:47] offset:1760
    s_mov_b64 exec, -1
    ds_read_b128 v[18:21], v104
    ds_read_b128 v[22:25], v104 offset:1024
    ds_read_b128 v[26:29], v104 offset:2048
    s_waitcnt vmcnt(2)
    ds_read_b128 v[120:123], v106
    ds_read_b128 v[10:13], v116
    ds_read_b128 v[124:127], v106 offset:64
    ds_read_b128 v[14:17], v116 offset:64
    ds_read_b128 v[40:43], v106 offset:256
    ds_read_b128 v[48:51], v106 offset:320
    s_waitcnt lgkmcnt(4)
    v_mfma_f32_16x16x32_bf16 v[52:55], v[18:21], v[120:123], 0
    v_mfma_f32_16x16x32_bf16 v[68:71], v[18:21], v[10:13], 0
    ds_read_b128 v[18:21], v104 offset:3072
    s_waitcnt lgkmcnt(3)
    v_mfma_f32_16x16x32_bf16 v[52:55], v[22:25], v[124:127], v[52:55]
    v_mfma_f32_16x16x32_bf16 v[68:71], v[22:25], v[14:17], v[68:71]
    ds_read_b128 v[22:25], v104 offset:4096
    v_mfma_f32_16x16x32_bf16 v[56:59], v[26:29], v[120:123], 0
    v_mfma_f32_16x16x32_bf16 v[72:75], v[26:29], v[10:13], 0
    ds_read_b128 v[26:29], v104 offset:5120
    s_waitcnt lgkmcnt(2)
    v_mfma_f32_16x16x32_bf16 v[56:59], v[18:21], v[124:127], v[56:59]
    v_mfma_f32_16x16x32_bf16 v[72:75], v[18:21], v[14:17], v[72:75]
    ds_read_b128 v[18:21], v104 offset:6144
    s_waitcnt lgkmcnt(2)
    v_mfma_f32_16x16x32_bf16 v[60:63], v[22:25], v[120:123], 0
    v_mfma_f32_16x16x32_bf16 v[76:79], v[22:25], v[10:13], 0
    ds_read_b128 v[22:25], v104 offset:7168
    s_waitcnt lgkmcnt(2)
    v_mfma_f32_16x16x32_bf16 v[60:63], v[26:29], v[124:127], v[60:63]
    v_mfma_f32_16x16x32_bf16 v[76:79], v[26:29], v[14:17], v[76:79]
    ds_read_b128 v[26:29], v104 offset:8192
    v_cvt_pk_bf16_f32 v52, v52, v53
    v_cvt_pk_bf16_f32 v53, v54, v55
    v_cvt_pk_bf16_f32 v54, v56, v57
    v_cvt_pk_bf16_f32 v55, v58, v59
    v_cvt_pk_bf16_f32 v68, v68, v69
    v_cvt_pk_bf16_f32 v69, v70, v71
    v_cvt_pk_bf16_f32 v70, v72, v73
    v_cvt_pk_bf16_f32 v71, v74, v75
    s_waitcnt lgkmcnt(2)
    v_mfma_f32_16x16x32_bf16 v[64:67], v[18:21], v[120:123], 0
    v_mfma_f32_16x16x32_bf16 v[80:83], v[18:21], v[10:13], 0
    ds_read_b128 v[18:21], v104 offset:9216
    s_waitcnt lgkmcnt(2)
    v_mfma_f32_16x16x32_bf16 v[64:67], v[22:25], v[124:127], v[64:67]
    v_mfma_f32_16x16x32_bf16 v[80:83], v[22:25], v[14:17], v[80:83]
    ds_read_b128 v[22:25], v104 offset:12288
    v_mfma_f32_16x16x32_bf16 v[56:59], v[120:123], v[52:55], 0
    v_mfma_f32_16x16x32_bf16 v[72:75], v[40:43], v[68:71], 0
    ds_read_b128 v[14:17], v108 offset:256
    ds_read_b32 v4, v109 offset:256
    ds_read_b32 v5, v110 offset:128
    s_nop 0
    v_cvt_pk_bf16_f32 v60, v60, v61
    v_cvt_pk_bf16_f32 v61, v62, v63
    v_cvt_pk_bf16_f32 v62, v64, v65
    v_cvt_pk_bf16_f32 v63, v66, v67
    v_cvt_pk_bf16_f32 v76, v76, v77
    v_cvt_pk_bf16_f32 v77, v78, v79
    v_cvt_pk_bf16_f32 v78, v80, v81
    v_cvt_pk_bf16_f32 v79, v82, v83
    s_nop 0
    v_mfma_f32_16x16x32_bf16 v[56:59], v[124:127], v[60:63], v[56:59]
    v_mfma_f32_16x16x32_bf16 v[72:75], v[48:51], v[76:79], v[72:75]
    s_setprio 2
    s_waitcnt lgkmcnt(5)
    v_mfma_f32_16x16x32_bf16 v[52:55], v[120:123], v[26:29], 0
    v_mfma_f32_16x16x32_bf16 v[68:71], v[40:43], v[26:29], 0
    ds_read_b128 v[26:29], v104 offset:13312
    s_waitcnt lgkmcnt(5)
    v_mfma_f32_16x16x32_bf16 v[52:55], v[124:127], v[18:21], v[52:55]
    v_mfma_f32_16x16x32_bf16 v[68:71], v[48:51], v[18:21], v[68:71]
    ds_read_b128 v[18:21], v104 offset:14336
    s_waitcnt lgkmcnt(5)
    v_mfma_f32_16x16x32_bf16 v[60:63], v[120:123], v[22:25], 0
    v_mfma_f32_16x16x32_bf16 v[76:79], v[40:43], v[22:25], 0
    ds_read_b128 v[22:25], v104 offset:15360
    s_waitcnt lgkmcnt(3)
    s_mov_b64 exec, s[14:15]
    v_pk_mul_f32 v[10:11], v[56:57], v[14:15]
    v_pk_mul_f32 v[12:13], v[58:59], v[16:17]
    s_mov_b64 exec, s[16:17]
    v_pk_mul_f32 v[10:11], v[72:73], v[14:15]
    v_pk_mul_f32 v[12:13], v[74:75], v[16:17]
    s_mov_b64 exec, -1
    v_mul_f32 v4, s74, v4
    v_cndmask_b32 v5, v5, 1.0, s[18:19]
    v_max3_f32 v2, v10, v11, v12
    v_max_f32 v2, v2, v13
    v_mov_b32 v3, v2
    s_waitcnt lgkmcnt(2)
    v_mfma_f32_16x16x32_bf16 v[60:63], v[124:127], v[26:29], v[60:63]
    v_mfma_f32_16x16x32_bf16 v[76:79], v[48:51], v[26:29], v[76:79]
    ds_read_b128 v[26:29], v104 offset:10240
    v_permlane16_swap_b32 v2, v3
    v_max_f32 v2, v2, v3
    v_mul_f32 v2, v4, v2
    v_pk_fma_f32 v[10:11], v[10:11], v[4:5], v[2:3] op_sel_hi:[1,0,0] neg_lo:[0,0,1] neg_hi:[0,0,1]
    v_pk_fma_f32 v[12:13], v[12:13], v[4:5], v[2:3] op_sel_hi:[1,0,0] neg_lo:[0,0,1] neg_hi:[0,0,1]
    v_exp_f32 v10, v10
    v_exp_f32 v11, v11
    v_exp_f32 v12, v12
    v_exp_f32 v13, v13
    s_waitcnt lgkmcnt(2)
    v_mfma_f32_16x16x32_bf16 v[64:67], v[120:123], v[18:21], 0
    v_mfma_f32_16x16x32_bf16 v[80:83], v[40:43], v[18:21], 0
    ds_read_b128 v[18:21], v104 offset:11264
    v_add_f32 v2, v10, v11
    v_add_f32 v3, v12, v13
    v_add_f32 v2, v2, v3
    v_mov_b32 v3, v2
    v_pk_mul_f32 v[10:11], v[10:11], v[14:15]
    v_pk_mul_f32 v[12:13], v[12:13], v[16:17]
    s_waitcnt lgkmcnt(2)
    v_mfma_f32_16x16x32_bf16 v[64:67], v[124:127], v[22:25], v[64:67]
    v_mfma_f32_16x16x32_bf16 v[80:83], v[48:51], v[22:25], v[80:83]
    v_permlane16_swap_b32 v2, v3
    v_add_f32 v2, v2, v3
    v_rcp_f32 v2, v2
    v_cvt_pk_bf16_f32 v55, v54, v55
    v_cvt_pk_bf16_f32 v54, v52, v53
    ds_read_b64_tr_b16 v[52:53], v107 offset:0
    v_cvt_pk_bf16_f32 v71, v70, v71
    v_cvt_pk_bf16_f32 v70, v68, v69
    ds_read_b64_tr_b16 v[68:69], v107 offset:256
    v_mul_f32 v2, v5, v2
    v_pk_mul_f32 v[10:11], v[10:11], v[2:3] op_sel_hi:[1,0]
    v_pk_mul_f32 v[12:13], v[12:13], v[2:3] op_sel_hi:[1,0]
    s_waitcnt lgkmcnt(3)
    v_mfma_f32_16x16x32_bf16 v[56:59], v[120:123], v[26:29], 0
    v_mfma_f32_16x16x32_bf16 v[72:75], v[40:43], v[26:29], 0
    s_mov_b64 exec, s[14:15]
    v_cvt_pk_bf16_f32 v94, v10, v11
    v_cvt_pk_bf16_f32 v95, v12, v13
    s_mov_b64 exec, s[16:17]
    v_cvt_pk_bf16_f32 v98, v10, v11
    v_cvt_pk_bf16_f32 v99, v12, v13
    s_mov_b64 exec, -1
    v_cvt_pk_bf16_f32 v63, v62, v63
    v_cvt_pk_bf16_f32 v62, v60, v61
    ds_read_b64_tr_b16 v[60:61], v107 offset:64
    v_cvt_pk_bf16_f32 v79, v78, v79
    v_cvt_pk_bf16_f32 v78, v76, v77
    ds_read_b64_tr_b16 v[76:77], v107 offset:320
    s_waitcnt lgkmcnt(4)
    v_mfma_f32_16x16x32_bf16 v[56:59], v[124:127], v[18:21], v[56:59]
    v_mfma_f32_16x16x32_bf16 v[72:75], v[48:51], v[18:21], v[72:75]
    v_cvt_pk_bf16_f32 v67, v66, v67
    v_cvt_pk_bf16_f32 v66, v64, v65
    ds_read_b64_tr_b16 v[64:65], v107 offset:72
    v_cvt_pk_bf16_f32 v83, v82, v83
    v_cvt_pk_bf16_f32 v82, v80, v81
    ds_read_b64_tr_b16 v[80:81], v107 offset:328
    ds_read_b32 v6, v111 offset:132
    ds_read_b32 v7, v114 offset:136
    v_cvt_pk_bf16_f32 v59, v58, v59
    v_cvt_pk_bf16_f32 v58, v56, v57
    ds_read_b64_tr_b16 v[56:57], v107 offset:8
    v_cvt_pk_bf16_f32 v75, v74, v75
    v_cvt_pk_bf16_f32 v74, v72, v73
    ds_read_b64_tr_b16 v[72:73], v107 offset:264
    s_setprio 1
    s_waitcnt lgkmcnt(9)
    v_mfma_f32_16x16x32_bf16 v[10:13], v[52:55], v[92:95], 0
    s_waitcnt lgkmcnt(7)
    v_mfma_f32_16x16x32_bf16 v[18:21], v[60:63], v[92:95], 0
    s_waitcnt lgkmcnt(5)
    v_mfma_f32_16x16x32_bf16 v[22:25], v[64:67], v[92:95], 0
    s_waitcnt lgkmcnt(1)
    v_mfma_f32_16x16x32_bf16 v[14:17], v[56:59], v[92:95], 0
    v_mfma_f32_16x16x32_bf16 v[52:55], v[68:71], v[96:99], 0
    v_mfma_f32_16x16x32_bf16 v[60:63], v[76:79], v[96:99], 0
    v_mfma_f32_16x16x32_bf16 v[64:67], v[80:83], v[96:99], 0
    s_waitcnt lgkmcnt(0)
    v_mfma_f32_16x16x32_bf16 v[56:59], v[72:75], v[96:99], 0
    v_cndmask_b32 v6, v6, 1.0, s[18:19]
    v_add_u32 v7, v7, v105
    v_cvt_pk_bf16_f32 v120, v10, v11
    v_cvt_pk_bf16_f32 v121, v12, v13
    v_cvt_pk_bf16_f32 v124, v18, v19
    v_cvt_pk_bf16_f32 v125, v20, v21
    v_cvt_pk_bf16_f32 v126, v22, v23
    v_cvt_pk_bf16_f32 v127, v24, v25
    v_cvt_pk_bf16_f32 v122, v14, v15
    v_cvt_pk_bf16_f32 v123, v16, v17
    ds_write_b128 v106, v[120:123]
    ds_write_b128 v106, v[124:127] offset:64
    v_cvt_pk_bf16_f32 v40, v52, v53
    v_cvt_pk_bf16_f32 v41, v54, v55
    v_cvt_pk_bf16_f32 v48, v60, v61
    v_cvt_pk_bf16_f32 v49, v62, v63
    v_cvt_pk_bf16_f32 v50, v64, v65
    v_cvt_pk_bf16_f32 v51, v66, v67
    v_cvt_pk_bf16_f32 v42, v56, v57
    v_cvt_pk_bf16_f32 v43, v58, v59
    ds_write_b128 v116, v[40:43]
    ds_write_b128 v116, v[48:51] offset:64
    v_mfma_f32_16x16x32_bf16 v[68:71], v[84:87], v[120:123], 0
    v_mfma_f32_16x16x32_bf16 v[72:75], v[84:87], v[40:43], 0
    v_mfma_f32_16x16x32_bf16 v[68:71], v[88:91], v[124:127], v[68:71]
    v_mfma_f32_16x16x32_bf16 v[72:75], v[88:91], v[48:51], v[72:75]
    ds_read_b64_tr_b16 v[10:11], v107 offset:0
    ds_read_b64_tr_b16 v[12:13], v107 offset:256
    ds_read_b64_tr_b16 v[14:15], v107 offset:8
    ds_read_b64_tr_b16 v[16:17], v107 offset:264
    ds_read_b64_tr_b16 v[18:19], v107 offset:64
    ds_read_b64_tr_b16 v[20:21], v107 offset:320
    ds_read_b64_tr_b16 v[22:23], v107 offset:72
    ds_read_b64_tr_b16 v[24:25], v107 offset:328
    s_setprio 0
    v_dot2_f32_bf16 v80, v120, v120, 0
    v_dot2_f32_bf16 v81, v40, v40, 0
    v_dot2_f32_bf16 v80, v121, v121, v80
    v_dot2_f32_bf16 v81, v41, v41, v81
    v_dot2_f32_bf16 v80, v122, v122, v80
    v_dot2_f32_bf16 v81, v42, v42, v81
    v_dot2_f32_bf16 v80, v123, v123, v80
    v_dot2_f32_bf16 v81, v43, v43, v81
    v_dot2_f32_bf16 v80, v124, v124, v80
    v_dot2_f32_bf16 v81, v48, v48, v81
    v_dot2_f32_bf16 v80, v125, v125, v80
    v_dot2_f32_bf16 v81, v49, v49, v81
    v_dot2_f32_bf16 v80, v126, v126, v80
    v_dot2_f32_bf16 v81, v50, v50, v81
    v_dot2_f32_bf16 v80, v127, v127, v80
    v_dot2_f32_bf16 v81, v51, v51, v81
    v_cndmask_b32 v68, v72, v68, s[20:21]
    v_cndmask_b32 v69, v73, v69, s[20:21]
    v_mul_f32 v82, 0x3e000000, v68
    v_permlane32_swap_b32 v80, v81
    v_add_f32 v80, v80, v81
    v_mov_b32 v81, v80
    v_fma_f32 v83, -v68, s55, v69
    v_mul_f32 v68, 0x3e000000, v6
    v_permlane16_swap_b32 v80, v81
    s_mov_b64 exec, s[72:73]
    v_add_f32 v80, v80, v81
    v_mul_f32 v68, v68, v68
    v_fma_f32 v80, -v82, v82, v80
    v_max_f32 v80, 0, v80
    v_fmaak_f32 v80, v68, v80, 0x3727c5ac
    v_rsq_f32 v80, v80
    v_mul_f32 v83, v6, v83
    v_mul_f32 v83, 0x3fb8aa3b, v83
    v_mul_f32 v80, v80, v83
    s_mov_b64 exec, s[10:11]
    v_add_u32 v106, 0x200, v106
    v_add_u32 v116, 0x200, v116
    s_mov_b64 exec, s[72:73]
    v_max_f32_dpp v81, v80, v80 quad_perm:[1,0,3,2] row_mask:0xf bank_mask:0xf
    s_nop 1
    v_max_f32_dpp v81, v81, v81 quad_perm:[2,3,0,1] row_mask:0xf bank_mask:0xf
    s_nop 1
    v_max_f32_dpp v81, v81, v81 row_half_mirror row_mask:0xf bank_mask:0xf
    v_sub_f32 v80, v80, v81
    v_exp_f32 v80, v80
    s_mov_b64 exec, s[12:13]
    v_add_u32 v107, 0x200, v107
    s_mov_b64 exec, s[72:73]
    v_add_f32_dpp v81, v80, v80 quad_perm:[1,0,3,2] row_mask:0xf bank_mask:0xf
    s_nop 1
    v_add_f32_dpp v81, v81, v81 quad_perm:[2,3,0,1] row_mask:0xf bank_mask:0xf
    s_nop 1
    v_add_f32_dpp v81, v81, v81 row_half_mirror row_mask:0xf bank_mask:0xf
    v_rcp_f32 v81, v81
    v_mul_f32 v80, v6, v80
    v_mul_f32 v80, v80, v81
    ds_write_b32 v112, v80 offset:256
    s_mov_b64 exec, -1
    ds_read_b128 v[68:71], v113 offset:256
    s_waitcnt lgkmcnt(2)
    s_mov_b32 exec_lo, 0
    s_mov_b32 exec_hi, -1
    s_sub_u32 m0, s95, 512
    s_nop 0
    buffer_load_dwordx4 v119, s[44:47], 0 offen  lds
    s_add_u32 m0, s95, 96
    s_nop 0
    buffer_load_dwordx4 v9, s[96:99], 0 offen sc1 lds
    s_add_u32 m0, s95, 672
    s_nop 0
    buffer_load_dwordx4 v9, s[32:35], 0 offen sc1 lds
    s_mov_b64 exec, -1
    s_setprio 0
    s_waitcnt lgkmcnt(0)
    s_mov_b64 exec, s[22:23]
    v_cvt_pk_bf16_f32 v100, v68, v69
    v_cvt_pk_bf16_f32 v101, v70, v71
    s_mov_b64 exec, s[8:9]
    v_cvt_pk_bf16_f32 v102, v68, v69
    v_cvt_pk_bf16_f32 v103, v70, v71
    s_mov_b64 exec, -1
    s_nop 0
    v_mfma_f32_16x16x32_bf16 v[52:55], v[10:13], v[100:103], 0
    v_mfma_f32_16x16x32_bf16 v[56:59], v[14:17], v[100:103], 0
    v_mfma_f32_16x16x32_bf16 v[60:63], v[18:21], v[100:103], 0
    v_mfma_f32_16x16x32_bf16 v[64:67], v[22:25], v[100:103], 0
    s_mov_b64 exec, s[70:71]
    s_nop 3
    v_cvt_pk_bf16_f32 v76, v52, v53
    v_cvt_pk_bf16_f32 v77, v54, v55
    v_cvt_pk_bf16_f32 v78, v56, v57
    v_cvt_pk_bf16_f32 v79, v58, v59
    v_cvt_pk_bf16_f32 v80, v60, v61
    v_cvt_pk_bf16_f32 v81, v62, v63
    v_cvt_pk_bf16_f32 v82, v64, v65
    v_cvt_pk_bf16_f32 v83, v66, v67
    buffer_store_dwordx4 v[76:79], v7, s[36:39], 0 offen sc1
    buffer_store_dwordx4 v[80:83], v7, s[36:39], 0 offen offset:64 sc1
    s_mov_b64 exec, -1
    s_setprio 0
    s_mov_b32 exec_lo, 0
    s_mov_b32 exec_hi, -1
    ds_write_b128 v115, v[44:47] offset:1760
    s_mov_b64 exec, -1
    ds_read_b128 v[18:21], v104
    ds_read_b128 v[22:25], v104 offset:1024
    ds_read_b128 v[26:29], v104 offset:2048
    s_waitcnt vmcnt(2)
    ds_read_b128 v[120:123], v106
    ds_read_b128 v[10:13], v116
    ds_read_b128 v[124:127], v106 offset:64
    ds_read_b128 v[14:17], v116 offset:64
    ds_read_b128 v[40:43], v106 offset:256
    ds_read_b128 v[48:51], v106 offset:320
    s_waitcnt lgkmcnt(4)
    v_mfma_f32_16x16x32_bf16 v[52:55], v[18:21], v[120:123], 0
    v_mfma_f32_16x16x32_bf16 v[68:71], v[18:21], v[10:13], 0
    ds_read_b128 v[18:21], v104 offset:3072
    s_waitcnt lgkmcnt(3)
    v_mfma_f32_16x16x32_bf16 v[52:55], v[22:25], v[124:127], v[52:55]
    v_mfma_f32_16x16x32_bf16 v[68:71], v[22:25], v[14:17], v[68:71]
    ds_read_b128 v[22:25], v104 offset:4096
    v_mfma_f32_16x16x32_bf16 v[56:59], v[26:29], v[120:123], 0
    v_mfma_f32_16x16x32_bf16 v[72:75], v[26:29], v[10:13], 0
    ds_read_b128 v[26:29], v104 offset:5120
    s_waitcnt lgkmcnt(2)
    v_mfma_f32_16x16x32_bf16 v[56:59], v[18:21], v[124:127], v[56:59]
    v_mfma_f32_16x16x32_bf16 v[72:75], v[18:21], v[14:17], v[72:75]
    ds_read_b128 v[18:21], v104 offset:6144
    s_waitcnt lgkmcnt(2)
    v_mfma_f32_16x16x32_bf16 v[60:63], v[22:25], v[120:123], 0
    v_mfma_f32_16x16x32_bf16 v[76:79], v[22:25], v[10:13], 0
    ds_read_b128 v[22:25], v104 offset:7168
    s_waitcnt lgkmcnt(2)
    v_mfma_f32_16x16x32_bf16 v[60:63], v[26:29], v[124:127], v[60:63]
    v_mfma_f32_16x16x32_bf16 v[76:79], v[26:29], v[14:17], v[76:79]
    ds_read_b128 v[26:29], v104 offset:8192
    v_cvt_pk_bf16_f32 v52, v52, v53
    v_cvt_pk_bf16_f32 v53, v54, v55
    v_cvt_pk_bf16_f32 v54, v56, v57
    v_cvt_pk_bf16_f32 v55, v58, v59
    v_cvt_pk_bf16_f32 v68, v68, v69
    v_cvt_pk_bf16_f32 v69, v70, v71
    v_cvt_pk_bf16_f32 v70, v72, v73
    v_cvt_pk_bf16_f32 v71, v74, v75
    s_waitcnt lgkmcnt(2)
    v_mfma_f32_16x16x32_bf16 v[64:67], v[18:21], v[120:123], 0
    v_mfma_f32_16x16x32_bf16 v[80:83], v[18:21], v[10:13], 0
    ds_read_b128 v[18:21], v104 offset:9216
    s_waitcnt lgkmcnt(2)
    v_mfma_f32_16x16x32_bf16 v[64:67], v[22:25], v[124:127], v[64:67]
    v_mfma_f32_16x16x32_bf16 v[80:83], v[22:25], v[14:17], v[80:83]
    ds_read_b128 v[22:25], v104 offset:12288
    v_mfma_f32_16x16x32_bf16 v[56:59], v[120:123], v[52:55], 0
    v_mfma_f32_16x16x32_bf16 v[72:75], v[40:43], v[68:71], 0
    ds_read_b128 v[14:17], v108 offset:384
    ds_read_b32 v4, v109 offset:384
    ds_read_b32 v5, v110 offset:192
    s_nop 0
    v_cvt_pk_bf16_f32 v60, v60, v61
    v_cvt_pk_bf16_f32 v61, v62, v63
    v_cvt_pk_bf16_f32 v62, v64, v65
    v_cvt_pk_bf16_f32 v63, v66, v67
    v_cvt_pk_bf16_f32 v76, v76, v77
    v_cvt_pk_bf16_f32 v77, v78, v79
    v_cvt_pk_bf16_f32 v78, v80, v81
    v_cvt_pk_bf16_f32 v79, v82, v83
    s_nop 0
    v_mfma_f32_16x16x32_bf16 v[56:59], v[124:127], v[60:63], v[56:59]
    v_mfma_f32_16x16x32_bf16 v[72:75], v[48:51], v[76:79], v[72:75]
    s_setprio 2
    s_waitcnt lgkmcnt(5)
    v_mfma_f32_16x16x32_bf16 v[52:55], v[120:123], v[26:29], 0
    v_mfma_f32_16x16x32_bf16 v[68:71], v[40:43], v[26:29], 0
    ds_read_b128 v[26:29], v104 offset:13312
    s_waitcnt lgkmcnt(5)
    v_mfma_f32_16x16x32_bf16 v[52:55], v[124:127], v[18:21], v[52:55]
    v_mfma_f32_16x16x32_bf16 v[68:71], v[48:51], v[18:21], v[68:71]
    ds_read_b128 v[18:21], v104 offset:14336
    s_waitcnt lgkmcnt(5)
    v_mfma_f32_16x16x32_bf16 v[60:63], v[120:123], v[22:25], 0
    v_mfma_f32_16x16x32_bf16 v[76:79], v[40:43], v[22:25], 0
    ds_read_b128 v[22:25], v104 offset:15360
    s_waitcnt lgkmcnt(3)
    s_mov_b64 exec, s[14:15]
    v_pk_mul_f32 v[10:11], v[56:57], v[14:15]
    v_pk_mul_f32 v[12:13], v[58:59], v[16:17]
    s_mov_b64 exec, s[16:17]
    v_pk_mul_f32 v[10:11], v[72:73], v[14:15]
    v_pk_mul_f32 v[12:13], v[74:75], v[16:17]
    s_mov_b64 exec, -1
    v_mul_f32 v4, s74, v4
    v_cndmask_b32 v5, v5, 1.0, s[18:19]
    v_max3_f32 v2, v10, v11, v12
    v_max_f32 v2, v2, v13
    v_mov_b32 v3, v2
    s_waitcnt lgkmcnt(2)
    v_mfma_f32_16x16x32_bf16 v[60:63], v[124:127], v[26:29], v[60:63]
    v_mfma_f32_16x16x32_bf16 v[76:79], v[48:51], v[26:29], v[76:79]
    ds_read_b128 v[26:29], v104 offset:10240
    v_permlane16_swap_b32 v2, v3
    v_max_f32 v2, v2, v3
    v_mul_f32 v2, v4, v2
    v_pk_fma_f32 v[10:11], v[10:11], v[4:5], v[2:3] op_sel_hi:[1,0,0] neg_lo:[0,0,1] neg_hi:[0,0,1]
    v_pk_fma_f32 v[12:13], v[12:13], v[4:5], v[2:3] op_sel_hi:[1,0,0] neg_lo:[0,0,1] neg_hi:[0,0,1]
    v_exp_f32 v10, v10
    v_exp_f32 v11, v11
    v_exp_f32 v12, v12
    v_exp_f32 v13, v13
    s_waitcnt lgkmcnt(2)
    v_mfma_f32_16x16x32_bf16 v[64:67], v[120:123], v[18:21], 0
    v_mfma_f32_16x16x32_bf16 v[80:83], v[40:43], v[18:21], 0
    ds_read_b128 v[18:21], v104 offset:11264
    v_add_f32 v2, v10, v11
    v_add_f32 v3, v12, v13
    v_add_f32 v2, v2, v3
    v_mov_b32 v3, v2
    v_pk_mul_f32 v[10:11], v[10:11], v[14:15]
    v_pk_mul_f32 v[12:13], v[12:13], v[16:17]
    s_waitcnt lgkmcnt(2)
    v_mfma_f32_16x16x32_bf16 v[64:67], v[124:127], v[22:25], v[64:67]
    v_mfma_f32_16x16x32_bf16 v[80:83], v[48:51], v[22:25], v[80:83]
    v_permlane16_swap_b32 v2, v3
    v_add_f32 v2, v2, v3
    v_rcp_f32 v2, v2
    v_cvt_pk_bf16_f32 v55, v54, v55
    v_cvt_pk_bf16_f32 v54, v52, v53
    ds_read_b64_tr_b16 v[52:53], v107 offset:0
    v_cvt_pk_bf16_f32 v71, v70, v71
    v_cvt_pk_bf16_f32 v70, v68, v69
    ds_read_b64_tr_b16 v[68:69], v107 offset:256
    v_mul_f32 v2, v5, v2
    v_pk_mul_f32 v[10:11], v[10:11], v[2:3] op_sel_hi:[1,0]
    v_pk_mul_f32 v[12:13], v[12:13], v[2:3] op_sel_hi:[1,0]
    s_waitcnt lgkmcnt(3)
    v_mfma_f32_16x16x32_bf16 v[56:59], v[120:123], v[26:29], 0
    v_mfma_f32_16x16x32_bf16 v[72:75], v[40:43], v[26:29], 0
    s_mov_b64 exec, s[14:15]
    v_cvt_pk_bf16_f32 v94, v10, v11
    v_cvt_pk_bf16_f32 v95, v12, v13
    s_mov_b64 exec, s[16:17]
    v_cvt_pk_bf16_f32 v98, v10, v11
    v_cvt_pk_bf16_f32 v99, v12, v13
    s_mov_b64 exec, -1
    v_cvt_pk_bf16_f32 v63, v62, v63
    v_cvt_pk_bf16_f32 v62, v60, v61
    ds_read_b64_tr_b16 v[60:61], v107 offset:64
    v_cvt_pk_bf16_f32 v79, v78, v79
    v_cvt_pk_bf16_f32 v78, v76, v77
    ds_read_b64_tr_b16 v[76:77], v107 offset:320
    s_waitcnt lgkmcnt(4)
    v_mfma_f32_16x16x32_bf16 v[56:59], v[124:127], v[18:21], v[56:59]
    v_mfma_f32_16x16x32_bf16 v[72:75], v[48:51], v[18:21], v[72:75]
    v_cvt_pk_bf16_f32 v67, v66, v67
    v_cvt_pk_bf16_f32 v66, v64, v65
    ds_read_b64_tr_b16 v[64:65], v107 offset:72
    v_cvt_pk_bf16_f32 v83, v82, v83
    v_cvt_pk_bf16_f32 v82, v80, v81
    ds_read_b64_tr_b16 v[80:81], v107 offset:328
    ds_read_b32 v6, v111 offset:196
    ds_read_b32 v7, v114 offset:200
    v_cvt_pk_bf16_f32 v59, v58, v59
    v_cvt_pk_bf16_f32 v58, v56, v57
    ds_read_b64_tr_b16 v[56:57], v107 offset:8
    v_cvt_pk_bf16_f32 v75, v74, v75
    v_cvt_pk_bf16_f32 v74, v72, v73
    ds_read_b64_tr_b16 v[72:73], v107 offset:264
    s_setprio 1
    s_waitcnt lgkmcnt(9)
    v_mfma_f32_16x16x32_bf16 v[10:13], v[52:55], v[92:95], 0
    s_waitcnt lgkmcnt(7)
    v_mfma_f32_16x16x32_bf16 v[18:21], v[60:63], v[92:95], 0
    s_waitcnt lgkmcnt(5)
    v_mfma_f32_16x16x32_bf16 v[22:25], v[64:67], v[92:95], 0
    s_waitcnt lgkmcnt(1)
    v_mfma_f32_16x16x32_bf16 v[14:17], v[56:59], v[92:95], 0
    v_mfma_f32_16x16x32_bf16 v[52:55], v[68:71], v[96:99], 0
    v_mfma_f32_16x16x32_bf16 v[60:63], v[76:79], v[96:99], 0
    v_mfma_f32_16x16x32_bf16 v[64:67], v[80:83], v[96:99], 0
    s_waitcnt lgkmcnt(0)
    v_mfma_f32_16x16x32_bf16 v[56:59], v[72:75], v[96:99], 0
    v_cndmask_b32 v6, v6, 1.0, s[18:19]
    v_add_u32 v7, v7, v105
    v_cvt_pk_bf16_f32 v120, v10, v11
    v_cvt_pk_bf16_f32 v121, v12, v13
    v_cvt_pk_bf16_f32 v124, v18, v19
    v_cvt_pk_bf16_f32 v125, v20, v21
    v_cvt_pk_bf16_f32 v126, v22, v23
    v_cvt_pk_bf16_f32 v127, v24, v25
    v_cvt_pk_bf16_f32 v122, v14, v15
    v_cvt_pk_bf16_f32 v123, v16, v17
    ds_write_b128 v106, v[120:123]
    ds_write_b128 v106, v[124:127] offset:64
    v_cvt_pk_bf16_f32 v40, v52, v53
    v_cvt_pk_bf16_f32 v41, v54, v55
    v_cvt_pk_bf16_f32 v48, v60, v61
    v_cvt_pk_bf16_f32 v49, v62, v63
    v_cvt_pk_bf16_f32 v50, v64, v65
    v_cvt_pk_bf16_f32 v51, v66, v67
    v_cvt_pk_bf16_f32 v42, v56, v57
    v_cvt_pk_bf16_f32 v43, v58, v59
    ds_write_b128 v116, v[40:43]
    ds_write_b128 v116, v[48:51] offset:64
    v_mfma_f32_16x16x32_bf16 v[68:71], v[84:87], v[120:123], 0
    v_mfma_f32_16x16x32_bf16 v[72:75], v[84:87], v[40:43], 0
    v_mfma_f32_16x16x32_bf16 v[68:71], v[88:91], v[124:127], v[68:71]
    v_mfma_f32_16x16x32_bf16 v[72:75], v[88:91], v[48:51], v[72:75]
    ds_read_b64_tr_b16 v[10:11], v107 offset:0
    ds_read_b64_tr_b16 v[12:13], v107 offset:256
    ds_read_b64_tr_b16 v[14:15], v107 offset:8
    ds_read_b64_tr_b16 v[16:17], v107 offset:264
    ds_read_b64_tr_b16 v[18:19], v107 offset:64
    ds_read_b64_tr_b16 v[20:21], v107 offset:320
    ds_read_b64_tr_b16 v[22:23], v107 offset:72
    ds_read_b64_tr_b16 v[24:25], v107 offset:328
    s_setprio 0
    v_dot2_f32_bf16 v80, v120, v120, 0
    v_dot2_f32_bf16 v81, v40, v40, 0
    v_dot2_f32_bf16 v80, v121, v121, v80
    v_dot2_f32_bf16 v81, v41, v41, v81
    v_dot2_f32_bf16 v80, v122, v122, v80
    v_dot2_f32_bf16 v81, v42, v42, v81
    v_dot2_f32_bf16 v80, v123, v123, v80
    v_dot2_f32_bf16 v81, v43, v43, v81
    v_dot2_f32_bf16 v80, v124, v124, v80
    v_dot2_f32_bf16 v81, v48, v48, v81
    v_dot2_f32_bf16 v80, v125, v125, v80
    v_dot2_f32_bf16 v81, v49, v49, v81
    v_dot2_f32_bf16 v80, v126, v126, v80
    v_dot2_f32_bf16 v81, v50, v50, v81
    v_dot2_f32_bf16 v80, v127, v127, v80
    v_dot2_f32_bf16 v81, v51, v51, v81
    v_cndmask_b32 v68, v72, v68, s[20:21]
    v_cndmask_b32 v69, v73, v69, s[20:21]
    v_mul_f32 v82, 0x3e000000, v68
    v_permlane32_swap_b32 v80, v81
    v_add_f32 v80, v80, v81
    v_mov_b32 v81, v80
    v_fma_f32 v83, -v68, s55, v69
    v_mul_f32 v68, 0x3e000000, v6
    v_permlane16_swap_b32 v80, v81
    s_mov_b64 exec, s[72:73]
    v_add_f32 v80, v80, v81
    v_mul_f32 v68, v68, v68
    v_fma_f32 v80, -v82, v82, v80
    v_max_f32 v80, 0, v80
    v_fmaak_f32 v80, v68, v80, 0x3727c5ac
    v_rsq_f32 v80, v80
    v_mul_f32 v83, v6, v83
    v_mul_f32 v83, 0x3fb8aa3b, v83
    v_mul_f32 v80, v80, v83
    s_nop 1
    v_max_f32_dpp v81, v80, v80 quad_perm:[1,0,3,2] row_mask:0xf bank_mask:0xf
    s_nop 1
    v_max_f32_dpp v81, v81, v81 quad_perm:[2,3,0,1] row_mask:0xf bank_mask:0xf
    s_nop 1
    v_max_f32_dpp v81, v81, v81 row_half_mirror row_mask:0xf bank_mask:0xf
    v_sub_f32 v80, v80, v81
    v_exp_f32 v80, v80
    s_nop 1
    v_add_f32_dpp v81, v80, v80 quad_perm:[1,0,3,2] row_mask:0xf bank_mask:0xf
    s_nop 1
    v_add_f32_dpp v81, v81, v81 quad_perm:[2,3,0,1] row_mask:0xf bank_mask:0xf
    s_nop 1
    v_add_f32_dpp v81, v81, v81 row_half_mirror row_mask:0xf bank_mask:0xf
    v_rcp_f32 v81, v81
    v_mul_f32 v80, v6, v80
    v_mul_f32 v80, v80, v81
    ds_write_b32 v112, v80 offset:384
    s_mov_b64 exec, -1
    ds_read_b128 v[68:71], v113 offset:384
    s_waitcnt lgkmcnt(2)
    s_setprio 0
    s_waitcnt lgkmcnt(0)
    s_mov_b64 exec, s[22:23]
    v_cvt_pk_bf16_f32 v100, v68, v69
    v_cvt_pk_bf16_f32 v101, v70, v71
    s_mov_b64 exec, s[8:9]
    v_cvt_pk_bf16_f32 v102, v68, v69
    v_cvt_pk_bf16_f32 v103, v70, v71
    s_mov_b64 exec, -1
    s_nop 0
    v_mfma_f32_16x16x32_bf16 v[52:55], v[10:13], v[100:103], 0
    v_mfma_f32_16x16x32_bf16 v[56:59], v[14:17], v[100:103], 0
    v_mfma_f32_16x16x32_bf16 v[60:63], v[18:21], v[100:103], 0
    v_mfma_f32_16x16x32_bf16 v[64:67], v[22:25], v[100:103], 0
    s_mov_b64 exec, s[70:71]
    s_nop 3
    v_cvt_pk_bf16_f32 v76, v52, v53
    v_cvt_pk_bf16_f32 v77, v54, v55
    v_cvt_pk_bf16_f32 v78, v56, v57
    v_cvt_pk_bf16_f32 v79, v58, v59
    v_cvt_pk_bf16_f32 v80, v60, v61
    v_cvt_pk_bf16_f32 v81, v62, v63
    v_cvt_pk_bf16_f32 v82, v64, v65
    v_cvt_pk_bf16_f32 v83, v66, v67
    buffer_store_dwordx4 v[76:79], v7, s[36:39], 0 offen sc1
    buffer_store_dwordx4 v[80:83], v7, s[36:39], 0 offen offset:64 sc1
    s_mov_b64 exec, -1
f_done:
k_end:
    s_endpgm
h_ev1:
    s_cmp_ge_u32 s78, 8
    s_cbranch_scc1 h_ev1_r
    s_add_u32 s78, s78, 1
    s_barrier
    s_add_u32 s77, s77, s52
    s_cbranch_scc0 h_ev1
    s_branch h_ev1_r
h_ev2:
    s_cmp_ge_u32 s78, 8
    s_cbranch_scc1 h_ev2_r
    s_add_u32 s78, s78, 1
    s_barrier
    s_add_u32 s77, s77, s52
    s_cbranch_scc0 h_ev2
    s_branch h_ev2_r
h_ev3:
    s_cmp_ge_u32 s78, 8
    s_cbranch_scc1 h_ev3_r
    s_add_u32 s78, s78, 1
    s_barrier
    s_add_u32 s77, s77, s52
    s_cbranch_scc0 h_ev3
    s_branch h_ev3_r
h_ev4:
    s_cmp_ge_u32 s78, 8
    s_cbranch_scc1 h_ev4_r
    s_add_u32 s78, s78, 1
    s_barrier
    s_add_u32 s77, s77, s52
    s_cbranch_scc0 h_ev4
    s_branch h_ev4_r
h_ev5:
    s_cmp_ge_u32 s78, 8
    s_cbranch_scc1 h_ev5_r
    s_add_u32 s78, s78, 1
    s_barrier
    s_add_u32 s77, s77, s52
    s_cbranch_scc0 h_ev5
    s_branch h_ev5_r
h_ev6:
    s_cmp_ge_u32 s78, 8
    s_cbranch_scc1 h_ev6_r
    s_add_u32 s78, s78, 1
    s_barrier
    s_add_u32 s77, s77, s52
    s_cbranch_scc0 h_ev6
    s_branch h_ev6_r
h_ev7:
    s_cmp_ge_u32 s78, 8
    s_cbranch_scc1 h_ev7_r
    s_add_u32 s78, s78, 1
    s_barrier
    s_add_u32 s77, s77, s52
    s_cbranch_scc0 h_ev7
    s_branch h_ev7_r
h_ev8:
    s_cmp_ge_u32 s78, 8
    s_cbranch_scc1 h_ev8_r
    s_add_u32 s78, s78, 1
    s_barrier
    s_add_u32 s77, s77, s52
    s_cbranch_scc0 h_ev8
    s_branch h_ev8_r
h_ev9:
    s_cmp_ge_u32 s78, 8
    s_cbranch_scc1 h_ev9_r
    s_add_u32 s78, s78, 1
    s_barrier
    s_add_u32 s77, s77, s52
    s_cbranch_scc0 h_ev9
    s_branch h_ev9_r
h_ev10:
    s_cmp_ge_u32 s78, 8
    s_cbranch_scc1 h_ev10_r
    s_add_u32 s78, s78, 1
    s_barrier
    s_add_u32 s77, s77, s52
    s_cbranch_scc0 h_ev10
    s_branch h_ev10_r
h_ev11:
    s_cmp_ge_u32 s78, 8
    s_cbranch_scc1 h_ev11_r
    s_add_u32 s78, s78, 1
    s_barrier
    s_add_u32 s77, s77, s52
    s_cbranch_scc0 h_ev11
    s_branch h_ev11_r
h_ev12:
    s_cmp_ge_u32 s78, 8
    s_cbranch_scc1 h_ev12_r
    s_add_u32 s78, s78, 1
    s_barrier
    s_add_u32 s77, s77, s52
    s_cbranch_scc0 h_ev12
    s_branch h_ev12_r
h_ev13:
    s_cmp_ge_u32 s78, 8
    s_cbranch_scc1 h_ev13_r
    s_add_u32 s78, s78, 1
    s_barrier
    s_add_u32 s77, s77, s52
    s_cbranch_scc0 h_ev13
    s_branch h_ev13_r
h_ev14:
    s_cmp_ge_u32 s78, 8
    s_cbranch_scc1 h_ev14_r
    s_add_u32 s78, s78, 1
    s_barrier
    s_add_u32 s77, s77, s52
    s_cbranch_scc0 h_ev14
    s_branch h_ev14_r
h_ev15:
    s_cmp_ge_u32 s78, 8
    s_cbranch_scc1 h_ev15_r
    s_add_u32 s78, s78, 1
    s_barrier
    s_add_u32 s77, s77, s52
    s_cbranch_scc0 h_ev15
    s_branch h_ev15_r
h_ev16:
    s_cmp_ge_u32 s78, 8
    s_cbranch_scc1 h_ev16_r
    s_add_u32 s78, s78, 1
    s_barrier
    s_add_u32 s77, s77, s52
    s_cbranch_scc0 h_ev16
    s_branch h_ev16_r
h_ev17:
    s_cmp_ge_u32 s78, 8
    s_cbranch_scc1 h_ev17_r
    s_add_u32 s78, s78, 1
    s_barrier
    s_add_u32 s77, s77, s52
    s_cbranch_scc0 h_ev17
    s_branch h_ev17_r
h_ev18:
    s_cmp_ge_u32 s78, 8
    s_cbranch_scc1 h_ev18_r
    s_add_u32 s78, s78, 1
    s_barrier
    s_add_u32 s77, s77, s52
    s_cbranch_scc0 h_ev18
    s_branch h_ev18_r
h_ev19:
    s_cmp_ge_u32 s78, 8
    s_cbranch_scc1 h_ev19_r
    s_add_u32 s78, s78, 1
    s_barrier
    s_add_u32 s77, s77, s52
    s_cbranch_scc0 h_ev19
    s_branch h_ev19_r
h_slow:
    s_mov_b32 s64, 40
    v_and_b32 v4, 3, v0
    v_lshlrev_b32 v4, 2, v4
h_sl:
    v_add_u32 v5, s64, v4
    v_add_u32 v6, v5, v122
    v_subrev_u32 v6, 40, v6
    v_lshlrev_b32 v6, 2, v6
    v_sub_u32 v5, v120, v5
    v_mov_b32 v7, 2147479552
    buffer_load_dwordx4 v[68:71], v6, s[40:43], s59 offen
    s_waitcnt vmcnt(0)
    v_cmp_lt_i32 vcc, 0, v5
    s_nop 1
    v_cndmask_b32 v68, v7, v68, vcc
    v_cmp_lt_i32 vcc, 1, v5
    s_nop 1
    v_cndmask_b32 v69, v7, v69, vcc
    v_cmp_lt_i32 vcc, 2, v5
    s_nop 1
    v_cndmask_b32 v70, v7, v70, vcc
    v_cmp_lt_i32 vcc, 3, v5
    s_nop 1
    v_cndmask_b32 v71, v7, v71, vcc
    s_nop 1
    v_add_u32_dpp v7, v68, v1 quad_perm:[0,0,0,0] row_mask:0xf bank_mask:0xf
    buffer_load_dwordx4 v[52:55], v7, s[32:35], 0 offen sc1
    v_add_u32_dpp v7, v69, v1 quad_perm:[0,0,0,0] row_mask:0xf bank_mask:0xf
    buffer_load_dwordx4 v[56:59], v7, s[32:35], 0 offen sc1
    v_add_u32_dpp v7, v70, v1 quad_perm:[0,0,0,0] row_mask:0xf bank_mask:0xf
    buffer_load_dwordx4 v[60:63], v7, s[32:35], 0 offen sc1
    v_add_u32_dpp v7, v71, v1 quad_perm:[0,0,0,0] row_mask:0xf bank_mask:0xf
    buffer_load_dwordx4 v[64:67], v7, s[32:35], 0 offen sc1
    s_waitcnt vmcnt(0)
    v_mfma_f32_4x4x4_16b_bf16 v[36:39], v[2:3], v[52:53], v[36:39]
    v_mfma_f32_4x4x4_16b_bf16 v[40:43], v[2:3], v[54:55], v[40:43]
    s_nop 0
    v_mfma_f32_4x4x4_16b_bf16 v[36:39], v[2:3], v[56:57], v[36:39]
    v_mfma_f32_4x4x4_16b_bf16 v[40:43], v[2:3], v[58:59], v[40:43]
    s_nop 0
    v_mfma_f32_4x4x4_16b_bf16 v[36:39], v[2:3], v[60:61], v[36:39]
    v_mfma_f32_4x4x4_16b_bf16 v[40:43], v[2:3], v[62:63], v[40:43]
    s_nop 0
    v_mfma_f32_4x4x4_16b_bf16 v[36:39], v[2:3], v[64:65], v[36:39]
    v_mfma_f32_4x4x4_16b_bf16 v[40:43], v[2:3], v[66:67], v[40:43]
    s_nop 0
    s_nop 1
    v_add_u32_dpp v7, v68, v1 quad_perm:[1,1,1,1] row_mask:0xf bank_mask:0xf
    buffer_load_dwordx4 v[52:55], v7, s[32:35], 0 offen sc1
    v_add_u32_dpp v7, v69, v1 quad_perm:[1,1,1,1] row_mask:0xf bank_mask:0xf
    buffer_load_dwordx4 v[56:59], v7, s[32:35], 0 offen sc1
    v_add_u32_dpp v7, v70, v1 quad_perm:[1,1,1,1] row_mask:0xf bank_mask:0xf
    buffer_load_dwordx4 v[60:63], v7, s[32:35], 0 offen sc1
    v_add_u32_dpp v7, v71, v1 quad_perm:[1,1,1,1] row_mask:0xf bank_mask:0xf
    buffer_load_dwordx4 v[64:67], v7, s[32:35], 0 offen sc1
    s_waitcnt vmcnt(0)
    v_mfma_f32_4x4x4_16b_bf16 v[36:39], v[2:3], v[52:53], v[36:39]
    v_mfma_f32_4x4x4_16b_bf16 v[40:43], v[2:3], v[54:55], v[40:43]
    s_nop 0
    v_mfma_f32_4x4x4_16b_bf16 v[36:39], v[2:3], v[56:57], v[36:39]
    v_mfma_f32_4x4x4_16b_bf16 v[40:43], v[2:3], v[58:59], v[40:43]
    s_nop 0
    v_mfma_f32_4x4x4_16b_bf16 v[36:39], v[2:3], v[60:61], v[36:39]
    v_mfma_f32_4x4x4_16b_bf16 v[40:43], v[2:3], v[62:63], v[40:43]
    s_nop 0
    v_mfma_f32_4x4x4_16b_bf16 v[36:39], v[2:3], v[64:65], v[36:39]
    v_mfma_f32_4x4x4_16b_bf16 v[40:43], v[2:3], v[66:67], v[40:43]
    s_nop 0
    s_nop 1
    v_add_u32_dpp v7, v68, v1 quad_perm:[2,2,2,2] row_mask:0xf bank_mask:0xf
    buffer_load_dwordx4 v[52:55], v7, s[32:35], 0 offen sc1
    v_add_u32_dpp v7, v69, v1 quad_perm:[2,2,2,2] row_mask:0xf bank_mask:0xf
    buffer_load_dwordx4 v[56:59], v7, s[32:35], 0 offen sc1
    v_add_u32_dpp v7, v70, v1 quad_perm:[2,2,2,2] row_mask:0xf bank_mask:0xf
    buffer_load_dwordx4 v[60:63], v7, s[32:35], 0 offen sc1
    v_add_u32_dpp v7, v71, v1 quad_perm:[2,2,2,2] row_mask:0xf bank_mask:0xf
    buffer_load_dwordx4 v[64:67], v7, s[32:35], 0 offen sc1
    s_waitcnt vmcnt(0)
    v_mfma_f32_4x4x4_16b_bf16 v[36:39], v[2:3], v[52:53], v[36:39]
    v_mfma_f32_4x4x4_16b_bf16 v[40:43], v[2:3], v[54:55], v[40:43]
    s_nop 0
    v_mfma_f32_4x4x4_16b_bf16 v[36:39], v[2:3], v[56:57], v[36:39]
    v_mfma_f32_4x4x4_16b_bf16 v[40:43], v[2:3], v[58:59], v[40:43]
    s_nop 0
    v_mfma_f32_4x4x4_16b_bf16 v[36:39], v[2:3], v[60:61], v[36:39]
    v_mfma_f32_4x4x4_16b_bf16 v[40:43], v[2:3], v[62:63], v[40:43]
    s_nop 0
    v_mfma_f32_4x4x4_16b_bf16 v[36:39], v[2:3], v[64:65], v[36:39]
    v_mfma_f32_4x4x4_16b_bf16 v[40:43], v[2:3], v[66:67], v[40:43]
    s_nop 0
    s_nop 1
    v_add_u32_dpp v7, v68, v1 quad_perm:[3,3,3,3] row_mask:0xf bank_mask:0xf
    buffer_load_dwordx4 v[52:55], v7, s[32:35], 0 offen sc1
    v_add_u32_dpp v7, v69, v1 quad_perm:[3,3,3,3] row_mask:0xf bank_mask:0xf
    buffer_load_dwordx4 v[56:59], v7, s[32:35], 0 offen sc1
    v_add_u32_dpp v7, v70, v1 quad_perm:[3,3,3,3] row_mask:0xf bank_mask:0xf
    buffer_load_dwordx4 v[60:63], v7, s[32:35], 0 offen sc1
    v_add_u32_dpp v7, v71, v1 quad_perm:[3,3,3,3] row_mask:0xf bank_mask:0xf
    buffer_load_dwordx4 v[64:67], v7, s[32:35], 0 offen sc1
    s_waitcnt vmcnt(0)
    v_mfma_f32_4x4x4_16b_bf16 v[36:39], v[2:3], v[52:53], v[36:39]
    v_mfma_f32_4x4x4_16b_bf16 v[40:43], v[2:3], v[54:55], v[40:43]
    s_nop 0
    v_mfma_f32_4x4x4_16b_bf16 v[36:39], v[2:3], v[56:57], v[36:39]
    v_mfma_f32_4x4x4_16b_bf16 v[40:43], v[2:3], v[58:59], v[40:43]
    s_nop 0
    v_mfma_f32_4x4x4_16b_bf16 v[36:39], v[2:3], v[60:61], v[36:39]
    v_mfma_f32_4x4x4_16b_bf16 v[40:43], v[2:3], v[62:63], v[40:43]
    s_nop 0
    v_mfma_f32_4x4x4_16b_bf16 v[36:39], v[2:3], v[64:65], v[36:39]
    v_mfma_f32_4x4x4_16b_bf16 v[40:43], v[2:3], v[66:67], v[40:43]
    s_nop 0
    v_add_u32 v5, s64, v4
    v_add_u32 v6, v5, v123
    v_subrev_u32 v6, 40, v6
    v_lshlrev_b32 v6, 2, v6
    v_sub_u32 v5, v121, v5
    v_mov_b32 v7, 2147479552
    buffer_load_dwordx4 v[68:71], v6, s[40:43], s59 offen
    s_waitcnt vmcnt(0)
    v_cmp_lt_i32 vcc, 0, v5
    s_nop 1
    v_cndmask_b32 v68, v7, v68, vcc
    v_cmp_lt_i32 vcc, 1, v5
    s_nop 1
    v_cndmask_b32 v69, v7, v69, vcc
    v_cmp_lt_i32 vcc, 2, v5
    s_nop 1
    v_cndmask_b32 v70, v7, v70, vcc
    v_cmp_lt_i32 vcc, 3, v5
    s_nop 1
    v_cndmask_b32 v71, v7, v71, vcc
    s_nop 1
    v_add_u32_dpp v7, v68, v1 quad_perm:[0,0,0,0] row_mask:0xf bank_mask:0xf
    buffer_load_dwordx4 v[52:55], v7, s[32:35], 0 offen sc1
    v_add_u32_dpp v7, v69, v1 quad_perm:[0,0,0,0] row_mask:0xf bank_mask:0xf
    buffer_load_dwordx4 v[56:59], v7, s[32:35], 0 offen sc1
    v_add_u32_dpp v7, v70, v1 quad_perm:[0,0,0,0] row_mask:0xf bank_mask:0xf
    buffer_load_dwordx4 v[60:63], v7, s[32:35], 0 offen sc1
    v_add_u32_dpp v7, v71, v1 quad_perm:[0,0,0,0] row_mask:0xf bank_mask:0xf
    buffer_load_dwordx4 v[64:67], v7, s[32:35], 0 offen sc1
    s_waitcnt vmcnt(0)
    v_mfma_f32_4x4x4_16b_bf16 v[44:47], v[2:3], v[52:53], v[44:47]
    v_mfma_f32_4x4x4_16b_bf16 v[48:51], v[2:3], v[54:55], v[48:51]
    s_nop 0
    v_mfma_f32_4x4x4_16b_bf16 v[44:47], v[2:3], v[56:57], v[44:47]
    v_mfma_f32_4x4x4_16b_bf16 v[48:51], v[2:3], v[58:59], v[48:51]
    s_nop 0
    v_mfma_f32_4x4x4_16b_bf16 v[44:47], v[2:3], v[60:61], v[44:47]
    v_mfma_f32_4x4x4_16b_bf16 v[48:51], v[2:3], v[62:63], v[48:51]
    s_nop 0
    v_mfma_f32_4x4x4_16b_bf16 v[44:47], v[2:3], v[64:65], v[44:47]
    v_mfma_f32_4x4x4_16b_bf16 v[48:51], v[2:3], v[66:67], v[48:51]
    s_nop 0
    s_nop 1
    v_add_u32_dpp v7, v68, v1 quad_perm:[1,1,1,1] row_mask:0xf bank_mask:0xf
    buffer_load_dwordx4 v[52:55], v7, s[32:35], 0 offen sc1
    v_add_u32_dpp v7, v69, v1 quad_perm:[1,1,1,1] row_mask:0xf bank_mask:0xf
    buffer_load_dwordx4 v[56:59], v7, s[32:35], 0 offen sc1
    v_add_u32_dpp v7, v70, v1 quad_perm:[1,1,1,1] row_mask:0xf bank_mask:0xf
    buffer_load_dwordx4 v[60:63], v7, s[32:35], 0 offen sc1
    v_add_u32_dpp v7, v71, v1 quad_perm:[1,1,1,1] row_mask:0xf bank_mask:0xf
    buffer_load_dwordx4 v[64:67], v7, s[32:35], 0 offen sc1
    s_waitcnt vmcnt(0)
    v_mfma_f32_4x4x4_16b_bf16 v[44:47], v[2:3], v[52:53], v[44:47]
    v_mfma_f32_4x4x4_16b_bf16 v[48:51], v[2:3], v[54:55], v[48:51]
    s_nop 0
    v_mfma_f32_4x4x4_16b_bf16 v[44:47], v[2:3], v[56:57], v[44:47]
    v_mfma_f32_4x4x4_16b_bf16 v[48:51], v[2:3], v[58:59], v[48:51]
    s_nop 0
    v_mfma_f32_4x4x4_16b_bf16 v[44:47], v[2:3], v[60:61], v[44:47]
    v_mfma_f32_4x4x4_16b_bf16 v[48:51], v[2:3], v[62:63], v[48:51]
    s_nop 0
    v_mfma_f32_4x4x4_16b_bf16 v[44:47], v[2:3], v[64:65], v[44:47]
    v_mfma_f32_4x4x4_16b_bf16 v[48:51], v[2:3], v[66:67], v[48:51]
    s_nop 0
    s_nop 1
    v_add_u32_dpp v7, v68, v1 quad_perm:[2,2,2,2] row_mask:0xf bank_mask:0xf
    buffer_load_dwordx4 v[52:55], v7, s[32:35], 0 offen sc1
    v_add_u32_dpp v7, v69, v1 quad_perm:[2,2,2,2] row_mask:0xf bank_mask:0xf
    buffer_load_dwordx4 v[56:59], v7, s[32:35], 0 offen sc1
    v_add_u32_dpp v7, v70, v1 quad_perm:[2,2,2,2] row_mask:0xf bank_mask:0xf
    buffer_load_dwordx4 v[60:63], v7, s[32:35], 0 offen sc1
    v_add_u32_dpp v7, v71, v1 quad_perm:[2,2,2,2] row_mask:0xf bank_mask:0xf
    buffer_load_dwordx4 v[64:67], v7, s[32:35], 0 offen sc1
    s_waitcnt vmcnt(0)
    v_mfma_f32_4x4x4_16b_bf16 v[44:47], v[2:3], v[52:53], v[44:47]
    v_mfma_f32_4x4x4_16b_bf16 v[48:51], v[2:3], v[54:55], v[48:51]
    s_nop 0
    v_mfma_f32_4x4x4_16b_bf16 v[44:47], v[2:3], v[56:57], v[44:47]
    v_mfma_f32_4x4x4_16b_bf16 v[48:51], v[2:3], v[58:59], v[48:51]
    s_nop 0
    v_mfma_f32_4x4x4_16b_bf16 v[44:47], v[2:3], v[60:61], v[44:47]
    v_mfma_f32_4x4x4_16b_bf16 v[48:51], v[2:3], v[62:63], v[48:51]
    s_nop 0
    v_mfma_f32_4x4x4_16b_bf16 v[44:47], v[2:3], v[64:65], v[44:47]
    v_mfma_f32_4x4x4_16b_bf16 v[48:51], v[2:3], v[66:67], v[48:51]
    s_nop 0
    s_nop 1
    v_add_u32_dpp v7, v68, v1 quad_perm:[3,3,3,3] row_mask:0xf bank_mask:0xf
    buffer_load_dwordx4 v[52:55], v7, s[32:35], 0 offen sc1
    v_add_u32_dpp v7, v69, v1 quad_perm:[3,3,3,3] row_mask:0xf bank_mask:0xf
    buffer_load_dwordx4 v[56:59], v7, s[32:35], 0 offen sc1
    v_add_u32_dpp v7, v70, v1 quad_perm:[3,3,3,3] row_mask:0xf bank_mask:0xf
    buffer_load_dwordx4 v[60:63], v7, s[32:35], 0 offen sc1
    v_add_u32_dpp v7, v71, v1 quad_perm:[3,3,3,3] row_mask:0xf bank_mask:0xf
    buffer_load_dwordx4 v[64:67], v7, s[32:35], 0 offen sc1
    s_waitcnt vmcnt(0)
    v_mfma_f32_4x4x4_16b_bf16 v[44:47], v[2:3], v[52:53], v[44:47]
    v_mfma_f32_4x4x4_16b_bf16 v[48:51], v[2:3], v[54:55], v[48:51]
    s_nop 0
    v_mfma_f32_4x4x4_16b_bf16 v[44:47], v[2:3], v[56:57], v[44:47]
    v_mfma_f32_4x4x4_16b_bf16 v[48:51], v[2:3], v[58:59], v[48:51]
    s_nop 0
    v_mfma_f32_4x4x4_16b_bf16 v[44:47], v[2:3], v[60:61], v[44:47]
    v_mfma_f32_4x4x4_16b_bf16 v[48:51], v[2:3], v[62:63], v[48:51]
    s_nop 0
    v_mfma_f32_4x4x4_16b_bf16 v[44:47], v[2:3], v[64:65], v[44:47]
    v_mfma_f32_4x4x4_16b_bf16 v[48:51], v[2:3], v[66:67], v[48:51]
    s_nop 0
    s_add_u32 s64, s64, 16
    s_cmp_lt_u32 s64, s53
    s_cbranch_scc1 h_sl
    s_branch h_slow_r
f_set:
    s_cmp_eq_u32 s3, 2
    s_cbranch_scc1 f_set2
    s_cmp_eq_u32 s3, 3
    s_cbranch_scc1 f_set3
    s_mul_i32 s95, s4, 2304
    s_add_u32 s95, s95, 127232
    s_xor_b32 s63, s61, 1
    s_mov_b32 s62, 0
    s_cmp_lg_u32 s4, 0
    s_cbranch_scc1 f_nb
    s_and_b32 s64, s2, 7
    s_lshr_b32 s65, s64, 2
    s_xor_b32 s65, s65, s63
    s_lshl_b32 s65, s65, 13
    s_lshl_b32 s64, s64, 8
    s_add_u32 s64, s64, s65
    s_add_u32 s56, s64, 98566144
    s_xor_b32 s65, s6, s63
    s_lshl_b32 s65, s65, 13
    s_and_b32 s64, s7, 7
    s_lshl_b32 s64, s64, 8
    s_add_u32 s64, s64, s65
    s_mov_b32 s75, 98570240
    s_add_u32 s57, s64, s75
f_nb:
    v_mov_b32 v4, 157184
    v_mov_b32 v5, 0
    ds_write_b32 v4, v5
    v_lshrrev_b32 v4, 4, v0
    v_lshl_add_u32 v4, v4, 5, s5
    v_and_b32 v4, 0xff, v4
    v_mul_u32_u24 v4, 196, v4
    v_and_b32 v5, 15, v0
    s_lshl_b32 s64, s4, 4
    s_sub_u32 s64, s64, 16
    v_add3_u32 v4, v4, v5, s64
    v_lshrrev_b32 v5, 8, v4
    v_mul_u32_u24 v6, 205, v5
    v_lshl_add_u32 v126, v5, 7, v4
    v_lshrrev_b32 v6, 13, v6
    v_lshrrev_b32 v5, 1, v4
    v_lshl_add_u32 v126, v6, 10, v126
    v_bitop3_b32 v5, v5, v4, 64 bitop3:0x80
    v_add_u32 v126, v126, v5
    v_lshrrev_b32 v5, 14, v126
    v_bfe_u32 v5, s58, v5, 1
    v_and_b32 v6, 128, v4
    v_lshrrev_b32 v6, 7, v6
    v_and_b32 v5, v5, v6
    v_lshl_add_u32 v126, v5, 6, v126
    v_lshlrev_b32 v126, 7, v126
    s_mov_b64 exec, s[48:49]
    v_lshrrev_b32 v4, 3, v116
    v_add_u32 v4, 107648, v4
    v_mov_b32 v52, v124
    v_mov_b32 v53, v14
    v_sub_u32 v54, v118, v1
    v_mov_b32 v55, 0
    ds_write_b128 v4, v[52:55]
    s_mov_b64 exec, s[50:51]
    v_lshrrev_b32 v4, 3, v116
    v_add_u32 v4, 107776, v4
    v_mov_b32 v52, v125
    v_mov_b32 v53, v15
    v_sub_u32 v54, v119, v1
    v_mov_b32 v55, 0
    ds_write_b128 v4, v[52:55]
    s_mov_b64 exec, -1
    v_lshrrev_b32 v4, 2, v0
    v_xor_b32 v4, s63, v4
    v_and_b32 v4, 1, v4
    v_lshlrev_b32 v4, 13, v4
    v_lshl_add_u32 v4, v0, 8, v4
    v_add_u32 v124, 98570240, v4
    s_branch f_setr1
f_set2:
    v_and_b32 v4, 15, v0
    v_lshrrev_b32 v5, 4, v0
    v_lshlrev_b32 v7, 4, v5
    s_lshl_b32 s64, s4, 11
    v_and_b32 v56, 7, v0
    v_lshrrev_b32 v57, 3, v4
    v_bfe_u32 v59, v0, 3, 2
    v_lshl_add_u32 v59, v59, 7, v1
    v_add_u32 v115, s95, v59
    v_lshlrev_b32 v59, 4, v5
    v_lshl_add_u32 v59, v57, 7, v59
    v_and_b32 v60, 3, v56
    v_lshl_add_u32 v59, v60, 6, v59
    v_lshrrev_b32 v60, 2, v56
    v_lshl_add_u32 v59, v60, 5, v59
    v_subrev_u32 v60, 1, v56
    v_cmp_gt_u32 s[10:11], 4, v60
    v_mul_u32_u24 v60, 25344, v60
    v_add3_u32 v60, v60, v59, s64
    v_subrev_u32 v106, 4, v56
    v_max_i32 v106, 0, v106
    v_lshl_add_u32 v106, v106, 9, v59
    v_add_u32 v106, s95, v106
    v_cndmask_b32 v106, v106, v60, s[10:11]
    v_lshrrev_b32 v58, 1, v5
    v_and_b32 v61, 1, v5
    v_bfe_u32 v62, v0, 2, 2
    v_lshl_add_u32 v61, v61, 2, v62
    v_and_b32 v6, 3, v0
    v_lshlrev_b32 v62, 8, v57
    v_sub_u32 v125, v106, v62
    v_add_u32 v125, 0x180, v125
    v_lshlrev_b32 v59, 4, v6
    v_lshl_add_u32 v59, v58, 7, v59
    v_and_b32 v60, 3, v61
    v_lshl_add_u32 v59, v60, 6, v59
    v_lshrrev_b32 v60, 2, v61
    v_lshl_add_u32 v59, v60, 5, v59
    v_subrev_u32 v60, 1, v61
    v_cmp_gt_u32 s[12:13], 4, v60
    v_mul_u32_u24 v60, 25344, v60
    v_add3_u32 v60, v60, v59, s64
    v_subrev_u32 v107, 4, v61
    v_max_i32 v107, 0, v107
    v_lshl_add_u32 v107, v107, 9, v59
    v_add_u32 v107, s95, v107
    v_cndmask_b32 v107, v107, v60, s[12:13]
    v_cmp_eq_u32 s[14:15], v58, v57
    v_cmp_ne_u32 s[16:17], v58, v57
    v_cmp_eq_u32 s[18:19], 0, v56
    v_cmp_gt_u32 s[20:21], 2, v5
    v_cmp_gt_u32 s[66:67], 2, v4
    s_lshl_b32 s64, s4, 9
    s_add_u32 s64, s64, 101376
    s_lshl_b32 s65, s4, 8
    s_add_u32 s65, s65, 107648
    v_lshlrev_b32 v59, 2, v4
    v_xor_b32 v60, 0x60, v59
    v_add_u32 v62, 64, v7
    v_cndmask_b32 v108, v62, v7, s[14:15]
    v_cndmask_b32 v109, v60, v59, s[14:15]
    v_cndmask_b32 v112, v60, v59, s[20:21]
    v_cndmask_b32 v113, v62, v7, s[66:67]
    v_lshlrev_b32 v59, 4, v57
    v_xor_b32 v60, 0x30, v59
    v_cndmask_b32 v110, v60, v59, s[14:15]
    v_cndmask_b32 v111, v60, v59, s[20:21]
    v_lshlrev_b32 v114, 4, v6
    v_add_u32 v108, s64, v108
    v_add_u32 v109, s64, v109
    v_add_u32 v112, s64, v112
    v_add_u32 v113, s64, v113
    v_add_u32 v110, s65, v110
    v_add_u32 v111, s65, v111
    v_add_u32 v114, s65, v114
    s_branch f_setr
f_set3:
    v_and_b32 v4, 15, v0
    v_lshrrev_b32 v5, 4, v0
    v_lshlrev_b32 v7, 4, v5
    v_lshrrev_b32 v58, 1, v5
    v_and_b32 v6, 3, v0
    v_lshlrev_b32 v59, 2, v5
    v_sub_u32 v60, v4, v59
    v_xor_b32 v61, 8, v4
    v_sub_u32 v61, v61, v59
    v_mov_b32 v62, 0x3f80
    v_mov_b32 v63, 0x3f800000
    v_cmp_eq_u32 s[66:67], 0, v60
    v_cmp_eq_u32 s[68:69], 1, v60
    v_mov_b32 v94, 0
    v_cndmask_b32 v92, 0, v62, s[66:67]
    v_cndmask_b32 v92, v92, v63, s[68:69]
    v_cmp_eq_u32 s[66:67], 2, v60
    v_cmp_eq_u32 s[68:69], 3, v60
    v_mov_b32 v95, 0
    v_cndmask_b32 v93, 0, v62, s[66:67]
    v_cndmask_b32 v93, v93, v63, s[68:69]
    v_cmp_eq_u32 s[66:67], 0, v61
    v_cmp_eq_u32 s[68:69], 1, v61
    v_mov_b32 v98, 0
    v_cndmask_b32 v96, 0, v62, s[66:67]
    v_cndmask_b32 v96, v96, v63, s[68:69]
    v_cmp_eq_u32 s[66:67], 2, v61
    v_cmp_eq_u32 s[68:69], 3, v61
    v_mov_b32 v99, 0
    v_cndmask_b32 v97, 0, v62, s[66:67]
    v_cndmask_b32 v97, v97, v63, s[68:69]
    v_mov_b32 v100, 0
    v_mov_b32 v101, 0
    v_mov_b32 v102, 0
    v_mov_b32 v103, 0
    v_cmp_eq_u32 s[22:23], v4, v58
    v_add_u32 v58, 2, v58
    v_cmp_eq_u32 s[8:9], v4, v58
    v_mov_b32 v105, v7
    v_lshlrev_b32 v104, 4, v0
    v_add_u32 v104, 110784, v104
    v_cmp_eq_u32 s[66:67], 0, v6
    v_cmp_eq_u32 s[68:69], 1, v6
    v_mov_b32 v59, s76
    v_dot2_f32_bf16 v61, v84, s76, 0
    v_dot2_f32_bf16 v61, v85, s76, v61
    v_dot2_f32_bf16 v61, v86, s76, v61
    v_dot2_f32_bf16 v61, v87, s76, v61
    v_dot2_f32_bf16 v61, v88, s76, v61
    v_dot2_f32_bf16 v61, v89, s76, v61
    v_dot2_f32_bf16 v61, v90, s76, v61
    v_dot2_f32_bf16 v61, v91, s76, v61
    v_cndmask_b32 v84, 0, v84, s[68:69]
    v_cndmask_b32 v84, v84, v59, s[66:67]
    v_cndmask_b32 v85, 0, v85, s[68:69]
    v_cndmask_b32 v85, v85, v59, s[66:67]
    v_cndmask_b32 v86, 0, v86, s[68:69]
    v_cndmask_b32 v86, v86, v59, s[66:67]
    v_cndmask_b32 v87, 0, v87, s[68:69]
    v_cndmask_b32 v87, v87, v59, s[66:67]
    v_cndmask_b32 v88, 0, v88, s[68:69]
    v_cndmask_b32 v88, v88, v59, s[66:67]
    v_cndmask_b32 v89, 0, v89, s[68:69]
    v_cndmask_b32 v89, v89, v59, s[66:67]
    v_cndmask_b32 v90, 0, v90, s[68:69]
    v_cndmask_b32 v90, v90, v59, s[66:67]
    v_cndmask_b32 v91, 0, v91, s[68:69]
    v_cndmask_b32 v91, v91, v59, s[66:67]
    v_readlane_b32 s64, v61, 0
    v_readlane_b32 s65, v61, 16
    v_readlane_b32 s66, v61, 32
    v_readlane_b32 s67, v61, 48
    v_mov_b32 v59, s64
    v_add_f32 v59, s65, v59
    v_add_f32 v59, s66, v59
    v_add_f32 v59, s67, v59
    v_mul_f32 v59, 0x3c800000, v59
    s_mov_b32 s74, 0x3e38aa3b
    v_readfirstlane_b32 s55, v59
    s_branch f_setr
h_def:
    v_lshlrev_b32 v116, 2, v115
    ds_read_b32 v122, v116 offset:32064
    ds_read_b32 v123, v116 offset:32096
    v_mov_b32 v6, 0x3f80
    v_mov_b32 v7, 0x3f800000
    v_cmp_eq_u32 s[70:71], 0, v114
    v_cmp_eq_u32 s[64:65], 1, v114
    v_cmp_eq_u32 s[66:67], 2, v114
    v_cmp_eq_u32 s[68:69], 3, v114
    v_cndmask_b32 v2, 0, v6, s[70:71]
    v_cndmask_b32 v3, 0, v6, s[66:67]
    v_cndmask_b32 v2, v2, v7, s[64:65]
    v_cndmask_b32 v3, v3, v7, s[68:69]
    s_movk_i32 s64, 196
    v_cmp_gt_u32 s[48:49], s64, v115
    s_movk_i32 s64, 188
    v_cmp_gt_u32 s[50:51], s64, v115
    v_lshlrev_b32 v116, 7, v115
    v_lshlrev_b32 v117, 5, v115
    v_add_u32 v117, 101376, v117
    s_waitcnt lgkmcnt(0)
    v_max_u32 v4, v101, v105
    v_mov_b32 v120, v101
    v_mov_b32 v121, v105
    v_max_u32_dpp v4, v4, v4 row_shr:8 row_mask:0xf bank_mask:0xf bound_ctrl:0
    s_nop 1
    v_max_u32_dpp v4, v4, v4 row_bcast:15 row_mask:0xa bank_mask:0xf
    s_nop 1
    v_max_u32_dpp v4, v4, v4 row_bcast:31 row_mask:0xc bank_mask:0xf
    s_nop 1
    v_readlane_b32 s53, v4, 63
    v_add_u32 v8, v102, v1
    v_add_u32 v10, v103, v1
    v_and_b32 v4, 0xffff0000, v100
    v_mul_f32 v12, v4, v4
    v_cmp_eq_f32 s[64:65], 0, v4
    v_and_b32 v5, 0xffff, v100
    v_add_u32 v5, s54, v5
    v_cndmask_b32 v124, v4, 1.0, s[64:65]
    v_lshl_add_u32 v118, v5, 7, v1
    v_cmp_gt_u32 s[64:65], s38, v102
    v_rcp_f32 v14, v124
    s_nop 0
    v_cndmask_b32 v118, v102, v118, s[64:65]
    v_add_u32 v9, v106, v1
    v_add_u32 v11, v107, v1
    v_and_b32 v4, 0xffff0000, v104
    v_mul_f32 v13, v4, v4
    v_cmp_eq_f32 s[64:65], 0, v4
    v_and_b32 v5, 0xffff, v104
    v_add_u32 v5, s54, v5
    v_cndmask_b32 v125, v4, 1.0, s[64:65]
    v_lshl_add_u32 v119, v5, 7, v1
    v_cmp_gt_u32 s[64:65], s38, v106
    v_rcp_f32 v15, v125
    s_nop 0
    v_cndmask_b32 v119, v106, v119, s[64:65]
    s_max_u32 s52, s53, 4
    s_min_u32 s52, s52, 40
    s_add_u32 s36, s36, 12582912
    s_addc_u32 s37, s37, 0
    s_mov_b32 s76, 0x3f803f80
    v_lshrrev_b32 v4, 4, v0
    v_lshlrev_b32 v4, 4, v4
    global_load_dwordx4 v[84:87], v4, s[24:25]
    global_load_dwordx4 v[88:91], v4, s[24:25] offset:64
    s_branch h_defr
ls1:
    v_mov_b32 v23, v20
    v_mov_b32 v24, v4
ls1_l:
    v_subrev_u32 v20, 32, v20
    v_add_u32 v24, 128, v24
    v_cmp_lt_i32 vcc, 0, v20
    s_cbranch_vccz ls1_r
    buffer_load_dwordx4 v[28:31], v24, s[40:43], 0 offen sc1
    buffer_load_dwordx4 v[32:35], v24, s[40:43], 0 offen offset:64 sc1
    s_waitcnt vmcnt(0)
    v_and_b32 v80, 0x1ffc, v28
    v_and_b32 v81, 0x1ffc, v29
    v_and_b32 v82, 0x1ffc, v30
    v_and_b32 v83, 0x1ffc, v31
    v_and_b32 v84, 0x1ffc, v32
    v_and_b32 v85, 0x1ffc, v33
    v_and_b32 v86, 0x1ffc, v34
    v_and_b32 v87, 0x1ffc, v35
    v_cmpx_lt_i32 vcc, 0, v20
    ds_add_u32 v80, v21 offset:32896
    v_cmpx_lt_i32 vcc, 1, v20
    ds_add_u32 v81, v21 offset:32896
    v_cmpx_lt_i32 vcc, 2, v20
    ds_add_u32 v82, v21 offset:32896
    v_cmpx_lt_i32 vcc, 3, v20
    ds_add_u32 v83, v21 offset:32896
    v_cmpx_lt_i32 vcc, 16, v20
    ds_add_u32 v84, v21 offset:32896
    v_cmpx_lt_i32 vcc, 17, v20
    ds_add_u32 v85, v21 offset:32896
    v_cmpx_lt_i32 vcc, 18, v20
    ds_add_u32 v86, v21 offset:32896
    v_cmpx_lt_i32 vcc, 19, v20
    ds_add_u32 v87, v21 offset:32896
    s_mov_b64 exec, -1
    s_branch ls1_l
ls1_r:
    v_mov_b32 v20, v23
    v_and_b32 v80, 0x1ffc, v12
    v_and_b32 v81, 0x1ffc, v13
    v_and_b32 v82, 0x1ffc, v14
    v_and_b32 v83, 0x1ffc, v15
    v_and_b32 v84, 0x1ffc, v16
    v_and_b32 v85, 0x1ffc, v17
    v_and_b32 v86, 0x1ffc, v18
    v_and_b32 v87, 0x1ffc, v19
    s_branch ls1_d
ls2:
    v_mov_b32 v23, v20
    v_mov_b32 v24, v4
ls2_l:
    v_subrev_u32 v20, 32, v20
    v_add_u32 v24, 128, v24
    v_cmp_lt_i32 vcc, 0, v20
    s_cbranch_vccz ls2_r
    buffer_load_dwordx4 v[28:31], v24, s[40:43], 0 offen sc1
    buffer_load_dwordx4 v[32:35], v24, s[40:43], 0 offen offset:64 sc1
    s_waitcnt vmcnt(0)
    v_and_b32 v80, 0x1ffc, v28
    v_and_b32 v81, 0x1ffc, v29
    v_and_b32 v82, 0x1ffc, v30
    v_and_b32 v83, 0x1ffc, v31
    v_and_b32 v84, 0x1ffc, v32
    v_and_b32 v85, 0x1ffc, v33
    v_and_b32 v86, 0x1ffc, v34
    v_and_b32 v87, 0x1ffc, v35
    v_lshrrev_b32 v26, 29, v28
    v_lshrrev_b32 v27, 8, v28
    v_bfe_u32 v26, s58, v26, 1
    v_and_b32 v27, 0xffffff80, v27
    v_and_b32 v26, v26, v28
    v_lshl_add_u32 v28, v26, 13, v27
    v_lshrrev_b32 v26, 29, v29
    v_lshrrev_b32 v27, 8, v29
    v_bfe_u32 v26, s58, v26, 1
    v_and_b32 v27, 0xffffff80, v27
    v_and_b32 v26, v26, v29
    v_lshl_add_u32 v29, v26, 13, v27
    v_lshrrev_b32 v26, 29, v30
    v_lshrrev_b32 v27, 8, v30
    v_bfe_u32 v26, s58, v26, 1
    v_and_b32 v27, 0xffffff80, v27
    v_and_b32 v26, v26, v30
    v_lshl_add_u32 v30, v26, 13, v27
    v_lshrrev_b32 v26, 29, v31
    v_lshrrev_b32 v27, 8, v31
    v_bfe_u32 v26, s58, v26, 1
    v_and_b32 v27, 0xffffff80, v27
    v_and_b32 v26, v26, v31
    v_lshl_add_u32 v31, v26, 13, v27
    v_lshrrev_b32 v26, 29, v32
    v_lshrrev_b32 v27, 8, v32
    v_bfe_u32 v26, s58, v26, 1
    v_and_b32 v27, 0xffffff80, v27
    v_and_b32 v26, v26, v32
    v_lshl_add_u32 v32, v26, 13, v27
    v_lshrrev_b32 v26, 29, v33
    v_lshrrev_b32 v27, 8, v33
    v_bfe_u32 v26, s58, v26, 1
    v_and_b32 v27, 0xffffff80, v27
    v_and_b32 v26, v26, v33
    v_lshl_add_u32 v33, v26, 13, v27
    v_lshrrev_b32 v26, 29, v34
    v_lshrrev_b32 v27, 8, v34
    v_bfe_u32 v26, s58, v26, 1
    v_and_b32 v27, 0xffffff80, v27
    v_and_b32 v26, v26, v34
    v_lshl_add_u32 v34, v26, 13, v27
    v_lshrrev_b32 v26, 29, v35
    v_lshrrev_b32 v27, 8, v35
    v_bfe_u32 v26, s58, v26, 1
    v_and_b32 v27, 0xffffff80, v27
    v_and_b32 v26, v26, v35
    v_lshl_add_u32 v35, v26, 13, v27
    v_cmpx_lt_i32 vcc, 0, v20
    ds_add_rtn_u32 v40, v80, v69 offset:32896
    v_cmpx_lt_i32 vcc, 1, v20
    ds_add_rtn_u32 v41, v81, v69 offset:32896
    v_cmpx_lt_i32 vcc, 2, v20
    ds_add_rtn_u32 v42, v82, v69 offset:32896
    v_cmpx_lt_i32 vcc, 3, v20
    ds_add_rtn_u32 v43, v83, v69 offset:32896
    v_cmpx_lt_i32 vcc, 16, v20
    ds_add_rtn_u32 v44, v84, v69 offset:32896
    v_cmpx_lt_i32 vcc, 17, v20
    ds_add_rtn_u32 v45, v85, v69 offset:32896
    v_cmpx_lt_i32 vcc, 18, v20
    ds_add_rtn_u32 v46, v86, v69 offset:32896
    v_cmpx_lt_i32 vcc, 19, v20
    ds_add_rtn_u32 v47, v87, v69 offset:32896
    s_mov_b64 exec, -1
    s_waitcnt lgkmcnt(0)
    v_cmp_lt_i32 s[70:71], 0, v20
    v_lshrrev_b32 v26, 22, v40
    v_and_b32 v22, s65, v40
    v_mul_u32_u24 v25, s64, v26
    v_sub_u32 v25, v22, v25
    v_lshrrev_b32 v25, 2, v25
    v_cmp_gt_u32 vcc, 40, v25
    s_and_b64 exec, s[70:71], vcc
    ds_write_b32 v22, v28 offset:52352
    s_andn2_b64 exec, s[70:71], vcc
    s_cbranch_execz ov9
    v_lshlrev_b32 v26, 2, v26
    ds_read_b32 v26, v26 offset:32064
    v_subrev_u32 v25, 40, v25
    s_waitcnt lgkmcnt(0)
    v_add_lshl_u32 v25, v25, v26, 2
    buffer_store_dword v28, v25, s[40:43], s59 offen
ov9:
    s_mov_b64 exec, -1
    v_cmp_lt_i32 s[70:71], 1, v20
    v_lshrrev_b32 v26, 22, v41
    v_and_b32 v22, s65, v41
    v_mul_u32_u24 v25, s64, v26
    v_sub_u32 v25, v22, v25
    v_lshrrev_b32 v25, 2, v25
    v_cmp_gt_u32 vcc, 40, v25
    s_and_b64 exec, s[70:71], vcc
    ds_write_b32 v22, v29 offset:52352
    s_andn2_b64 exec, s[70:71], vcc
    s_cbranch_execz ov10
    v_lshlrev_b32 v26, 2, v26
    ds_read_b32 v26, v26 offset:32064
    v_subrev_u32 v25, 40, v25
    s_waitcnt lgkmcnt(0)
    v_add_lshl_u32 v25, v25, v26, 2
    buffer_store_dword v29, v25, s[40:43], s59 offen
ov10:
    s_mov_b64 exec, -1
    v_cmp_lt_i32 s[70:71], 2, v20
    v_lshrrev_b32 v26, 22, v42
    v_and_b32 v22, s65, v42
    v_mul_u32_u24 v25, s64, v26
    v_sub_u32 v25, v22, v25
    v_lshrrev_b32 v25, 2, v25
    v_cmp_gt_u32 vcc, 40, v25
    s_and_b64 exec, s[70:71], vcc
    ds_write_b32 v22, v30 offset:52352
    s_andn2_b64 exec, s[70:71], vcc
    s_cbranch_execz ov11
    v_lshlrev_b32 v26, 2, v26
    ds_read_b32 v26, v26 offset:32064
    v_subrev_u32 v25, 40, v25
    s_waitcnt lgkmcnt(0)
    v_add_lshl_u32 v25, v25, v26, 2
    buffer_store_dword v30, v25, s[40:43], s59 offen
ov11:
    s_mov_b64 exec, -1
    v_cmp_lt_i32 s[70:71], 3, v20
    v_lshrrev_b32 v26, 22, v43
    v_and_b32 v22, s65, v43
    v_mul_u32_u24 v25, s64, v26
    v_sub_u32 v25, v22, v25
    v_lshrrev_b32 v25, 2, v25
    v_cmp_gt_u32 vcc, 40, v25
    s_and_b64 exec, s[70:71], vcc
    ds_write_b32 v22, v31 offset:52352
    s_andn2_b64 exec, s[70:71], vcc
    s_cbranch_execz ov12
    v_lshlrev_b32 v26, 2, v26
    ds_read_b32 v26, v26 offset:32064
    v_subrev_u32 v25, 40, v25
    s_waitcnt lgkmcnt(0)
    v_add_lshl_u32 v25, v25, v26, 2
    buffer_store_dword v31, v25, s[40:43], s59 offen
ov12:
    s_mov_b64 exec, -1
    v_cmp_lt_i32 s[70:71], 16, v20
    v_lshrrev_b32 v26, 22, v44
    v_and_b32 v22, s65, v44
    v_mul_u32_u24 v25, s64, v26
    v_sub_u32 v25, v22, v25
    v_lshrrev_b32 v25, 2, v25
    v_cmp_gt_u32 vcc, 40, v25
    s_and_b64 exec, s[70:71], vcc
    ds_write_b32 v22, v32 offset:52352
    s_andn2_b64 exec, s[70:71], vcc
    s_cbranch_execz ov13
    v_lshlrev_b32 v26, 2, v26
    ds_read_b32 v26, v26 offset:32064
    v_subrev_u32 v25, 40, v25
    s_waitcnt lgkmcnt(0)
    v_add_lshl_u32 v25, v25, v26, 2
    buffer_store_dword v32, v25, s[40:43], s59 offen
ov13:
    s_mov_b64 exec, -1
    v_cmp_lt_i32 s[70:71], 17, v20
    v_lshrrev_b32 v26, 22, v45
    v_and_b32 v22, s65, v45
    v_mul_u32_u24 v25, s64, v26
    v_sub_u32 v25, v22, v25
    v_lshrrev_b32 v25, 2, v25
    v_cmp_gt_u32 vcc, 40, v25
    s_and_b64 exec, s[70:71], vcc
    ds_write_b32 v22, v33 offset:52352
    s_andn2_b64 exec, s[70:71], vcc
    s_cbranch_execz ov14
    v_lshlrev_b32 v26, 2, v26
    ds_read_b32 v26, v26 offset:32064
    v_subrev_u32 v25, 40, v25
    s_waitcnt lgkmcnt(0)
    v_add_lshl_u32 v25, v25, v26, 2
    buffer_store_dword v33, v25, s[40:43], s59 offen
ov14:
    s_mov_b64 exec, -1
    v_cmp_lt_i32 s[70:71], 18, v20
    v_lshrrev_b32 v26, 22, v46
    v_and_b32 v22, s65, v46
    v_mul_u32_u24 v25, s64, v26
    v_sub_u32 v25, v22, v25
    v_lshrrev_b32 v25, 2, v25
    v_cmp_gt_u32 vcc, 40, v25
    s_and_b64 exec, s[70:71], vcc
    ds_write_b32 v22, v34 offset:52352
    s_andn2_b64 exec, s[70:71], vcc
    s_cbranch_execz ov15
    v_lshlrev_b32 v26, 2, v26
    ds_read_b32 v26, v26 offset:32064
    v_subrev_u32 v25, 40, v25
    s_waitcnt lgkmcnt(0)
    v_add_lshl_u32 v25, v25, v26, 2
    buffer_store_dword v34, v25, s[40:43], s59 offen
ov15:
    s_mov_b64 exec, -1
    v_cmp_lt_i32 s[70:71], 19, v20
    v_lshrrev_b32 v26, 22, v47
    v_and_b32 v22, s65, v47
    v_mul_u32_u24 v25, s64, v26
    v_sub_u32 v25, v22, v25
    v_lshrrev_b32 v25, 2, v25
    v_cmp_gt_u32 vcc, 40, v25
    s_and_b64 exec, s[70:71], vcc
    ds_write_b32 v22, v35 offset:52352
    s_andn2_b64 exec, s[70:71], vcc
    s_cbranch_execz ov16
    v_lshlrev_b32 v26, 2, v26
    ds_read_b32 v26, v26 offset:32064
    v_subrev_u32 v25, 40, v25
    s_waitcnt lgkmcnt(0)
    v_add_lshl_u32 v25, v25, v26, 2
    buffer_store_dword v35, v25, s[40:43], s59 offen
ov16:
    s_mov_b64 exec, -1
    s_branch ls2_l
ls2_r:
    v_mov_b32 v20, v23
    v_and_b32 v80, 0x1ffc, v12
    v_and_b32 v81, 0x1ffc, v13
    v_and_b32 v82, 0x1ffc, v14
    v_and_b32 v83, 0x1ffc, v15
    v_and_b32 v84, 0x1ffc, v16
    v_and_b32 v85, 0x1ffc, v17
    v_and_b32 v86, 0x1ffc, v18
    v_and_b32 v87, 0x1ffc, v19
    s_branch ls2_d
p2_ovf:
    v_cmp_eq_u32 vcc, 0, v3
    s_mov_b64 exec, vcc
    ds_add_u32 v62, v9 offset:4
    s_mov_b64 exec, -1
    s_waitcnt lgkmcnt(0)
    s_barrier
    ds_read_b32 v63, v62 offset:4
    s_waitcnt lgkmcnt(0)
    v_readfirstlane_b32 s59, v63
    s_lshl_b32 s59, s59, 2
    s_add_u32 s59, s59, 5242880
    v_cmp_lt_i32 s[70:71], 0, v20
    v_lshrrev_b32 v26, 22, v40
    v_and_b32 v22, s65, v40
    v_mul_u32_u24 v25, s64, v26
    v_sub_u32 v25, v22, v25
    v_lshrrev_b32 v25, 2, v25
    v_cmp_gt_u32 vcc, 40, v25
    s_and_b64 exec, s[70:71], vcc
    ds_write_b32 v22, v12 offset:52352
    s_andn2_b64 exec, s[70:71], vcc
    s_cbranch_execz ov17
    v_lshlrev_b32 v26, 2, v26
    ds_read_b32 v26, v26 offset:32064
    v_subrev_u32 v25, 40, v25
    s_waitcnt lgkmcnt(0)
    v_add_lshl_u32 v25, v25, v26, 2
    buffer_store_dword v12, v25, s[40:43], s59 offen
ov17:
    s_mov_b64 exec, -1
    v_cmp_lt_i32 s[70:71], 1, v20
    v_lshrrev_b32 v26, 22, v41
    v_and_b32 v22, s65, v41
    v_mul_u32_u24 v25, s64, v26
    v_sub_u32 v25, v22, v25
    v_lshrrev_b32 v25, 2, v25
    v_cmp_gt_u32 vcc, 40, v25
    s_and_b64 exec, s[70:71], vcc
    ds_write_b32 v22, v13 offset:52352
    s_andn2_b64 exec, s[70:71], vcc
    s_cbranch_execz ov18
    v_lshlrev_b32 v26, 2, v26
    ds_read_b32 v26, v26 offset:32064
    v_subrev_u32 v25, 40, v25
    s_waitcnt lgkmcnt(0)
    v_add_lshl_u32 v25, v25, v26, 2
    buffer_store_dword v13, v25, s[40:43], s59 offen
ov18:
    s_mov_b64 exec, -1
    v_cmp_lt_i32 s[70:71], 2, v20
    v_lshrrev_b32 v26, 22, v42
    v_and_b32 v22, s65, v42
    v_mul_u32_u24 v25, s64, v26
    v_sub_u32 v25, v22, v25
    v_lshrrev_b32 v25, 2, v25
    v_cmp_gt_u32 vcc, 40, v25
    s_and_b64 exec, s[70:71], vcc
    ds_write_b32 v22, v14 offset:52352
    s_andn2_b64 exec, s[70:71], vcc
    s_cbranch_execz ov19
    v_lshlrev_b32 v26, 2, v26
    ds_read_b32 v26, v26 offset:32064
    v_subrev_u32 v25, 40, v25
    s_waitcnt lgkmcnt(0)
    v_add_lshl_u32 v25, v25, v26, 2
    buffer_store_dword v14, v25, s[40:43], s59 offen
ov19:
    s_mov_b64 exec, -1
    v_cmp_lt_i32 s[70:71], 3, v20
    v_lshrrev_b32 v26, 22, v43
    v_and_b32 v22, s65, v43
    v_mul_u32_u24 v25, s64, v26
    v_sub_u32 v25, v22, v25
    v_lshrrev_b32 v25, 2, v25
    v_cmp_gt_u32 vcc, 40, v25
    s_and_b64 exec, s[70:71], vcc
    ds_write_b32 v22, v15 offset:52352
    s_andn2_b64 exec, s[70:71], vcc
    s_cbranch_execz ov20
    v_lshlrev_b32 v26, 2, v26
    ds_read_b32 v26, v26 offset:32064
    v_subrev_u32 v25, 40, v25
    s_waitcnt lgkmcnt(0)
    v_add_lshl_u32 v25, v25, v26, 2
    buffer_store_dword v15, v25, s[40:43], s59 offen
ov20:
    s_mov_b64 exec, -1
    v_cmp_lt_i32 s[70:71], 16, v20
    v_lshrrev_b32 v26, 22, v44
    v_and_b32 v22, s65, v44
    v_mul_u32_u24 v25, s64, v26
    v_sub_u32 v25, v22, v25
    v_lshrrev_b32 v25, 2, v25
    v_cmp_gt_u32 vcc, 40, v25
    s_and_b64 exec, s[70:71], vcc
    ds_write_b32 v22, v16 offset:52352
    s_andn2_b64 exec, s[70:71], vcc
    s_cbranch_execz ov21
    v_lshlrev_b32 v26, 2, v26
    ds_read_b32 v26, v26 offset:32064
    v_subrev_u32 v25, 40, v25
    s_waitcnt lgkmcnt(0)
    v_add_lshl_u32 v25, v25, v26, 2
    buffer_store_dword v16, v25, s[40:43], s59 offen
ov21:
    s_mov_b64 exec, -1
    v_cmp_lt_i32 s[70:71], 17, v20
    v_lshrrev_b32 v26, 22, v45
    v_and_b32 v22, s65, v45
    v_mul_u32_u24 v25, s64, v26
    v_sub_u32 v25, v22, v25
    v_lshrrev_b32 v25, 2, v25
    v_cmp_gt_u32 vcc, 40, v25
    s_and_b64 exec, s[70:71], vcc
    ds_write_b32 v22, v17 offset:52352
    s_andn2_b64 exec, s[70:71], vcc
    s_cbranch_execz ov22
    v_lshlrev_b32 v26, 2, v26
    ds_read_b32 v26, v26 offset:32064
    v_subrev_u32 v25, 40, v25
    s_waitcnt lgkmcnt(0)
    v_add_lshl_u32 v25, v25, v26, 2
    buffer_store_dword v17, v25, s[40:43], s59 offen
ov22:
    s_mov_b64 exec, -1
    v_cmp_lt_i32 s[70:71], 18, v20
    v_lshrrev_b32 v26, 22, v46
    v_and_b32 v22, s65, v46
    v_mul_u32_u24 v25, s64, v26
    v_sub_u32 v25, v22, v25
    v_lshrrev_b32 v25, 2, v25
    v_cmp_gt_u32 vcc, 40, v25
    s_and_b64 exec, s[70:71], vcc
    ds_write_b32 v22, v18 offset:52352
    s_andn2_b64 exec, s[70:71], vcc
    s_cbranch_execz ov23
    v_lshlrev_b32 v26, 2, v26
    ds_read_b32 v26, v26 offset:32064
    v_subrev_u32 v25, 40, v25
    s_waitcnt lgkmcnt(0)
    v_add_lshl_u32 v25, v25, v26, 2
    buffer_store_dword v18, v25, s[40:43], s59 offen
ov23:
    s_mov_b64 exec, -1
    v_cmp_lt_i32 s[70:71], 19, v20
    v_lshrrev_b32 v26, 22, v47
    v_and_b32 v22, s65, v47
    v_mul_u32_u24 v25, s64, v26
    v_sub_u32 v25, v22, v25
    v_lshrrev_b32 v25, 2, v25
    v_cmp_gt_u32 vcc, 40, v25
    s_and_b64 exec, s[70:71], vcc
    ds_write_b32 v22, v19 offset:52352
    s_andn2_b64 exec, s[70:71], vcc
    s_cbranch_execz ov24
    v_lshlrev_b32 v26, 2, v26
    ds_read_b32 v26, v26 offset:32064
    v_subrev_u32 v25, 40, v25
    s_waitcnt lgkmcnt(0)
    v_add_lshl_u32 v25, v25, v26, 2
    buffer_store_dword v19, v25, s[40:43], s59 offen
ov24:
    s_mov_b64 exec, -1
    s_branch p2_ovd
.section .rodata,"a"
.p2align 6
.amdhsa_kernel gather_scatter__hybrid_graph_tf_nagphormer__graph_kernel
  .amdhsa_next_free_vgpr 128
  .amdhsa_next_free_sgpr 102
  .amdhsa_accum_offset 128
  .amdhsa_group_segment_fixed_size 0
  .amdhsa_kernarg_size 96
  .amdhsa_user_sgpr_count 2
  .amdhsa_user_sgpr_kernarg_segment_ptr 1
  .amdhsa_system_sgpr_workgroup_id_x 1
  .amdhsa_float_denorm_mode_32 3
.end_amdhsa_kernel
```
